```python
import torch

def _softmax(x, axis=-1):
    return torch.softmax(x, dim=axis)
def _gelu(x):
    return torch.nn.functional.gelu(x, approximate="tanh")
def _silu(x):
    return torch.nn.functional.silu(x)
def _sigmoid(x):
    return torch.sigmoid(x)
def _layernorm(x, axis=-1, eps=1e-5):
    m = x.mean(dim=axis, keepdim=True)
    v = x.var(dim=axis, keepdim=True, unbiased=False)
    return (x - m) / torch.sqrt(v + eps)
def _scatter_add(tgt, idx, src, axis=0):
    return tgt.clone().index_add_(axis, idx, src)
def _segment_sum(src, seg, n):
    out = torch.zeros((n,) + src.shape[1:], dtype=src.dtype)
    return out.index_add_(0, seg, src)
def _pad(x, pw):
    flat = tuple(v for pair in reversed(pw) for v in pair)
    return torch.nn.functional.pad(x, flat)

kernel_name = 'recurrent_scan__sliding_block_cached__glu_gated_reglu__decode'

def setup_inputs():

    _w = (lambda a: (lambda t: t.to(torch.bfloat16) if t.is_floating_point() else t)(torch.as_tensor(a)))
    def _A_setup():
        B, Sq, D = 1, 1, 640
        Hq, Hkv, Sk, Dh = 32, 32, 32768, 192
        assert Hq % Hkv == 0, (Hq, Hkv)
        return {
            "x": _w((lambda *s: torch.randn(*s, dtype=torch.bfloat16) * 0.2)(B, Sq, D)),
            "k_cache": _w((lambda *s: torch.randn(*s, dtype=torch.bfloat16) * 1.6)(B, Hkv, Sk, Dh)),
            "v_cache": _w((lambda *s: torch.randn(*s, dtype=torch.bfloat16) * 1.6)(B, Hkv, Sk, Dh)),
            "wq": _w((lambda *s: torch.randn(*s, dtype=torch.bfloat16) * 1.6)(D, Hq * Dh) * (D ** -0.5)),
            "wo": _w((lambda *s: torch.randn(*s, dtype=torch.bfloat16) * 1.6)(Hq * Dh, D) * ((Hq * Dh) ** -0.5)),
        }
    _A_in = _A_setup()

    def _B_setup():
        B, S, D, F = 1, 1, 640, 1536
        return {
            "x": _w((lambda *s: torch.randn(*s, dtype=torch.bfloat16) * 0.2)(B, S, D)),
            "W_gate": _w((lambda *s: torch.randn(*s, dtype=torch.bfloat16) * 0.8)(D, F) * (2.0 / D) ** 0.5),
            "W_up": _w((lambda *s: torch.randn(*s, dtype=torch.bfloat16) * 0.8)(D, F) * (2.0 / D) ** 0.5),
            "W_down": _w((lambda *s: torch.randn(*s, dtype=torch.bfloat16) * 0.8)(F, D) * (1.0 / F) ** 0.5),
        }
    _B_in = _B_setup()

    return {
        "A_x": _A_in["x"],
        "A_k_cache": _A_in["k_cache"],
        "A_v_cache": _A_in["v_cache"],
        "A_wq": _A_in["wq"],
        "A_wo": _A_in["wo"],
        "B_x": _B_in["x"],
        "B_W_gate": _B_in["W_gate"],
        "B_W_up": _B_in["W_up"],
        "B_W_down": _B_in["W_down"],
    }

def reference(A_x, A_k_cache, A_v_cache, A_wq, A_wo, B_x, B_W_gate, B_W_up, B_W_down):
    def _A_ref(x, k_cache, v_cache, wq, wo):
        B, Sq, D = x.shape
        Hq, Dh = 32, 192
        Hkv, Sk = k_cache.shape[1], k_cache.shape[2]
        W = min(4096, max(256, Sk // 4))
        rep = Hq // Hkv
        q = (lambda x, *d: x.permute(*d))((x @ wq).reshape(B, Sq, Hq, Dh), 0, 2, 1, 3)
        k = (lambda x, n, axis: torch.repeat_interleave(x, n, dim=axis))(k_cache[:, :, Sk - W:, :], rep, axis=1)
        v = (lambda x, n, axis: torch.repeat_interleave(x, n, dim=axis))(v_cache[:, :, Sk - W:, :], rep, axis=1)
        scores = torch.einsum("bhqd,bhkd->bhqk", q, k) * (Dh ** -0.5)
        p = _softmax(scores, axis=-1)
        o = torch.einsum("bhqk,bhkd->bhqd", p, v)
        return (lambda x, *d: x.permute(*d))(o, 0, 2, 1, 3).reshape(B, Sq, Hq * Dh) @ wo

    def _B_ref(x, W_gate, W_up, W_down):
        gate = torch.einsum("bsd,df->bsf", x, W_gate)
        up = torch.einsum("bsd,df->bsf", x, W_up)
        gate = gate * (lambda x, dt: x.to(dt))(gate > 0, gate.dtype)
        h = gate * up
        return torch.einsum("bsf,fd->bsd", h, W_down)

    x = A_x
    xn = _layernorm(x, axis=-1)
    s = _A_ref(xn, A_k_cache, A_v_cache, A_wq, A_wo)
    g = _silu(_B_ref(xn, B_W_gate, B_W_up, B_W_down))
    return x + s * g
```

```asm
; @launch grid=(256,1,1) block=(512,1,1) lds=36864
.amdgcn_target "amdgcn-amd-amdhsa--gfx950"
.text
.globl recurrent_scan__sliding_block_cached__glu_gated_reglu__decode_kernel
.p2align 8
.type recurrent_scan__sliding_block_cached__glu_gated_reglu__decode_kernel,@function
recurrent_scan__sliding_block_cached__glu_gated_reglu__decode_kernel:
    s_load_dwordx16 s[4:19], s[0:1], 0
    s_load_dwordx8 s[20:27], s[0:1], 64
    s_cmp_ge_u32 s2, 256
    s_cbranch_scc1 L_exit
    v_lshrrev_b32 v14, 6, v0
    v_and_b32 v1, 63, v0
    v_readfirstlane_b32 s56, v14
    v_lshrrev_b32 v2, 3, v1
    v_and_b32 v3, 7, v1
    s_lshr_b32 s57, s2, 3
    s_and_b32 s58, s2, 7
    s_mul_i32 s59, s2, 1366
    s_lshr_b32 s59, s59, 16
    s_mul_i32 s78, s59, 48
    s_sub_u32 s60, s2, s78
    s_lshl_b32 s64, s58, 3
    s_add_u32 s64, s64, s56
    s_mul_i32 s64, s64, 3072
    s_lshl_b32 s93, s57, 8
    s_add_u32 s93, s93, 32768
    v_mul_u32_u24 v4, 384, v2
    v_lshl_add_u32 v4, v3, 4, v4
    s_cmp_lt_u32 s60, 32
    s_movk_i32 s72, 3072
    s_cselect_b32 s72, 12288, s72
    s_cselect_b32 s79, 0, 32
    s_cmp_ge_u32 s60, 40
    s_cselect_b32 s79, 40, s79
    s_sub_u32 s79, s60, s79
    s_lshl_b32 s80, s59, 7
    s_lshl_b32 s81, s56, 4
    s_add_u32 s80, s80, s81
    s_mul_i32 s61, s80, s72
    s_mul_i32 s79, s79, 384
    s_add_u32 s61, s61, s79
    s_add_u32 s62, s61, s72
    s_lshl_b32 s80, s80, 1
    s_lshl_b32 s81, s72, 1
    v_mul_lo_u32 v5, v2, s81
    v_lshl_add_u32 v5, v3, 4, v5
    v_lshlrev_b32 v14, 4, v1
    v_lshlrev_b32 v15, 2, v1
    v_lshlrev_b32 v16, 2, v2
    s_mul_i32 s82, s57, 12582912
    s_add_u32 s82, s82, 11010048
    s_waitcnt lgkmcnt(0)
    s_load_dword s66, s[26:27], 0
    s_mov_b32 s44, s26
    s_and_b32 s45, s27, 0xffff
    s_mov_b32 s46, 2097152
    s_mov_b32 s47, 0x00020000
    s_mov_b32 s48, s4
    s_and_b32 s49, s5, 0xffff
    s_mov_b32 s50, 1280
    s_mov_b32 s51, 0x00020000
    s_cmp_lt_u32 s60, 40
    s_cselect_b32 s36, s16, s18
    s_cselect_b32 s37, s17, s19
    s_cmp_lt_u32 s60, 32
    s_cselect_b32 s36, s10, s36
    s_cselect_b32 s37, s11, s37
    s_mov_b32 s38, 1966080
    s_cselect_b32 s38, 7864320, s38
    s_and_b32 s37, s37, 0xffff
    s_mov_b32 s39, 0x00020000
    s_add_u32 s28, s6, s82
    s_addc_u32 s29, s7, 0
    s_and_b32 s29, s29, 0xffff
    s_mov_b32 s30, 1572864
    s_mov_b32 s31, 0x00020000
    s_add_u32 s32, s8, s82
    s_addc_u32 s33, s9, 0
    s_and_b32 s33, s33, 0xffff
    s_mov_b32 s34, 1572864
    s_mov_b32 s35, 0x00020000
    s_cmp_ge_u32 s2, 240
    s_cbranch_scc1 L_noP1
    s_lshl_b32 s83, s2, 3
    s_or_b32 s83, s83, s56
    s_and_b32 s83, s83, 0xffffff07
    s_cmp_lg_u32 s83, 0
    s_cbranch_scc1 L_noinit
    s_lshl_b32 s83, s2, 8
    s_add_u32 s83, s83, 32768
    v_mov_b32 v13, 256
    s_mov_b64 exec, 1
    buffer_store_dword v13, off, s[44:47], s83 sc1
    s_mov_b64 exec, -1
L_noinit:
    buffer_load_dwordx4 v[18:21], v14, s[48:51], 0 offen
    buffer_load_dword v22, v15, s[48:51], 0 offen offset:1024
    buffer_load_dword v23, v16, s[48:51], s80 offen
    s_barrier
    buffer_load_dwordx4 v[96:99], v5, s[36:39], s61 offen offset:0 nt
    buffer_load_dwordx4 v[100:103], v5, s[36:39], s61 offen offset:128 nt
    buffer_load_dwordx4 v[104:107], v5, s[36:39], s61 offen offset:256 nt
    buffer_load_dwordx4 v[108:111], v5, s[36:39], s62 offen offset:0 nt
    buffer_load_dwordx4 v[112:115], v5, s[36:39], s62 offen offset:128 nt
    buffer_load_dwordx4 v[116:119], v5, s[36:39], s62 offen offset:256 nt
    s_barrier
    s_mov_b32 s67, 0x3fb8aa3b
    s_mov_b32 s68, 0x3d93cd3a
    s_mov_b32 s73, 0x05040100
    s_mov_b32 s74, 0x07060302
    s_mov_b32 s52, s22
    s_and_b32 s53, s23, 0xffff
    s_mov_b32 s54, 1280
    s_mov_b32 s55, 0x00020000
    s_mov_b32 s40, s12
    s_and_b32 s41, s13, 0xffff
    s_mov_b32 s42, 0
    s_mov_b32 s43, 0x00020000
    s_mov_b32 s63, 0
    v_and_b32 v24, 15, v1
    v_lshlrev_b32 v24, 4, v24
    v_mul_u32_u24 v6, 3840, v2
    v_add_u32 v6, v6, v24
    v_xor_b32 v224, 1, v2
    v_mul_u32_u24 v224, 3840, v224
    v_add_u32 v224, v224, v24
    v_mov_b32 v226, v24
    v_xor_b32 v227, 1, v2
    s_lshl_b32 s78, s56, 10
    v_lshl_add_u32 v228, v1, 4, s78
    s_mov_b32 s75, 0
    s_mov_b32 s76, 0
    v_lshrrev_b32 v225, 4, v1
    v_lshlrev_b32 v225, 3, v225
    v_lshl_add_u32 v225, v24, 1, v225
    s_lshl_b32 s78, s56, 9
    v_add_u32 v225, s78, v225
    s_lshl_b32 s78, s56, 10
    v_lshl_add_u32 v24, v3, 3, v2
    v_add_u32 v25, 0, v24
    v_mul_u32_u24 v26, 21846, v25
    v_lshrrev_b32 v26, 16, v26
    v_add_u32 v25, v25, v26
    v_lshl_add_u32 v8, v25, 2, s78
    v_add_u32 v25, 64, v24
    v_mul_u32_u24 v26, 21846, v25
    v_lshrrev_b32 v26, 16, v26
    v_add_u32 v25, v25, v26
    v_lshl_add_u32 v9, v25, 2, s78
    v_add_u32 v25, 128, v24
    v_mul_u32_u24 v26, 21846, v25
    v_lshrrev_b32 v26, 16, v26
    v_add_u32 v25, v25, v26
    v_lshl_add_u32 v10, v25, 2, s78
    v_mov_b32 v11, 0xf149f2ca
    v_mov_b32 v12, 0
    s_waitcnt vmcnt(6)
    v_lshlrev_b32 v68, 16, v18
    v_and_b32 v69, 0xffff0000, v18
    v_lshlrev_b32 v70, 16, v19
    v_and_b32 v71, 0xffff0000, v19
    v_lshlrev_b32 v72, 16, v20
    v_and_b32 v73, 0xffff0000, v20
    v_lshlrev_b32 v74, 16, v21
    v_and_b32 v75, 0xffff0000, v21
    v_lshlrev_b32 v76, 16, v22
    v_and_b32 v77, 0xffff0000, v22
    v_add_f32 v78, v68, v69
    v_add_f32 v79, v70, v71
    v_add_f32 v80, v72, v73
    v_add_f32 v78, v78, v74
    v_add_f32 v79, v79, v75
    v_add_f32 v80, v80, v76
    v_add_f32 v78, v78, v77
    v_add_f32 v79, v79, v80
    v_add_f32 v78, v78, v79
    s_nop 1
    v_add_f32_dpp v78, v78, v78 row_ror:8 row_mask:0xf bank_mask:0xf
    s_nop 1
    v_add_f32_dpp v78, v78, v78 row_ror:4 row_mask:0xf bank_mask:0xf
    s_nop 1
    v_add_f32_dpp v78, v78, v78 row_ror:2 row_mask:0xf bank_mask:0xf
    s_nop 1
    v_add_f32_dpp v78, v78, v78 row_ror:1 row_mask:0xf bank_mask:0xf
    v_mov_b32 v79, v78
    s_nop 1
    v_permlane16_swap_b32 v78, v79
    v_add_f32 v78, v78, v79
    v_mov_b32 v79, v78
    s_nop 1
    v_permlane32_swap_b32 v78, v79
    v_add_f32 v78, v78, v79
    s_nop 0
    v_readfirstlane_b32 s78, v78
    s_nop 1
    v_mov_b32 v78, s78
    s_mov_b32 s78, 0x3acccccd
    s_mov_b32 s79, 0xc4200000
    v_mul_f32 v79, s78, v78
    v_fma_f32 v80, v79, s79, v78
    v_fma_f32 v78, v80, s78, v79
    v_sub_f32 v68, v68, v78
    v_sub_f32 v69, v69, v78
    v_sub_f32 v70, v70, v78
    v_sub_f32 v71, v71, v78
    v_sub_f32 v72, v72, v78
    v_sub_f32 v73, v73, v78
    v_sub_f32 v74, v74, v78
    v_sub_f32 v75, v75, v78
    v_sub_f32 v76, v76, v78
    v_sub_f32 v77, v77, v78
    v_mul_f32 v79, v68, v68
    v_mul_f32 v80, v69, v69
    v_fma_f32 v79, v70, v70, v79
    v_fma_f32 v80, v71, v71, v80
    v_fma_f32 v79, v72, v72, v79
    v_fma_f32 v80, v73, v73, v80
    v_fma_f32 v79, v74, v74, v79
    v_fma_f32 v80, v75, v75, v80
    v_fma_f32 v79, v76, v76, v79
    v_fma_f32 v80, v77, v77, v80
    v_add_f32 v79, v79, v80
    s_nop 1
    v_add_f32_dpp v79, v79, v79 row_ror:8 row_mask:0xf bank_mask:0xf
    s_nop 1
    v_add_f32_dpp v79, v79, v79 row_ror:4 row_mask:0xf bank_mask:0xf
    s_nop 1
    v_add_f32_dpp v79, v79, v79 row_ror:2 row_mask:0xf bank_mask:0xf
    s_nop 1
    v_add_f32_dpp v79, v79, v79 row_ror:1 row_mask:0xf bank_mask:0xf
    v_mov_b32 v80, v79
    s_nop 1
    v_permlane16_swap_b32 v79, v80
    v_add_f32 v79, v79, v80
    v_mov_b32 v80, v79
    s_nop 1
    v_permlane32_swap_b32 v79, v80
    v_add_f32 v79, v79, v80
    s_nop 0
    v_readfirstlane_b32 s78, v79
    s_nop 1
    v_mov_b32 v79, s78
    s_mov_b32 s78, 0x3acccccd
    s_mov_b32 s79, 0xc4200000
    v_mul_f32 v80, s78, v79
    v_fma_f32 v68, v80, s79, v79
    v_fma_f32 v79, v68, s78, v80
    v_cvt_pk_bf16_f32 v79, 0, v79
    v_add_f32 v79, 0x3727c5ac, v79
    v_cvt_pk_bf16_f32 v79, 0, v79
    v_sqrt_f32 v79, v79
    s_nop 0
    v_cvt_pk_bf16_f32 v79, 0, v79
    v_rcp_f32 v79, v79
    v_cvt_pk_bf16_f32 v78, 0, v78
    v_lshlrev_b32 v68, 16, v23
    v_and_b32 v69, 0xffff0000, v23
    v_sub_f32 v68, v68, v78
    v_sub_f32 v69, v69, v78
    v_cvt_pk_bf16_f32 v68, 0, v68
    v_cvt_pk_bf16_f32 v69, 0, v69
    v_mul_f32 v68, v68, v79
    v_mul_f32 v69, v69, v79
    v_cvt_pk_bf16_f32 v70, v68, 0
    v_cvt_pk_bf16_f32 v71, 0, v68
    v_cvt_pk_bf16_f32 v72, v69, 0
    v_cvt_pk_bf16_f32 v73, 0, v69
    s_waitcnt lgkmcnt(0)
    s_xor_b32 s65, s66, 0x5b3d1f37
    v_mov_b32 v7, s65
    s_waitcnt vmcnt(4)
    buffer_load_dwordx4 v[128:131], v4, s[28:31], s64 offen offset:0 nt
    s_waitcnt vmcnt(4)
    buffer_load_dwordx4 v[132:135], v4, s[28:31], s64 offen offset:128 nt
    s_waitcnt vmcnt(4)
    buffer_load_dwordx4 v[136:139], v4, s[28:31], s64 offen offset:256 nt
    s_waitcnt vmcnt(4)
    buffer_load_dwordx4 v[140:143], v4, s[32:35], s64 offen offset:0 nt
    s_waitcnt vmcnt(4)
    buffer_load_dwordx4 v[144:147], v4, s[32:35], s64 offen offset:128 nt
    v_dot2_f32_bf16 v32, v96, v70, 0
    v_dot2_f32_bf16 v33, v96, v71, 0
    v_dot2_f32_bf16 v34, v97, v70, 0
    v_dot2_f32_bf16 v35, v97, v71, 0
    v_dot2_f32_bf16 v36, v98, v70, 0
    v_dot2_f32_bf16 v37, v98, v71, 0
    v_dot2_f32_bf16 v38, v99, v70, 0
    v_dot2_f32_bf16 v39, v99, v71, 0
    v_dot2_f32_bf16 v40, v100, v70, 0
    v_dot2_f32_bf16 v41, v100, v71, 0
    v_dot2_f32_bf16 v42, v101, v70, 0
    v_dot2_f32_bf16 v43, v101, v71, 0
    v_dot2_f32_bf16 v44, v102, v70, 0
    v_dot2_f32_bf16 v45, v102, v71, 0
    v_dot2_f32_bf16 v46, v103, v70, 0
    v_dot2_f32_bf16 v47, v103, v71, 0
    v_dot2_f32_bf16 v48, v104, v70, 0
    v_dot2_f32_bf16 v49, v104, v71, 0
    v_dot2_f32_bf16 v50, v105, v70, 0
    v_dot2_f32_bf16 v51, v105, v71, 0
    v_dot2_f32_bf16 v52, v106, v70, 0
    v_dot2_f32_bf16 v53, v106, v71, 0
    v_dot2_f32_bf16 v54, v107, v70, 0
    v_dot2_f32_bf16 v55, v107, v71, 0
    v_dot2c_f32_bf16 v32, v108, v72
    v_dot2c_f32_bf16 v33, v108, v73
    v_dot2c_f32_bf16 v34, v109, v72
    v_dot2c_f32_bf16 v35, v109, v73
    v_dot2c_f32_bf16 v36, v110, v72
    v_dot2c_f32_bf16 v37, v110, v73
    v_dot2c_f32_bf16 v38, v111, v72
    v_dot2c_f32_bf16 v39, v111, v73
    v_dot2c_f32_bf16 v40, v112, v72
    v_dot2c_f32_bf16 v41, v112, v73
    v_dot2c_f32_bf16 v42, v113, v72
    v_dot2c_f32_bf16 v43, v113, v73
    v_dot2c_f32_bf16 v44, v114, v72
    v_dot2c_f32_bf16 v45, v114, v73
    v_dot2c_f32_bf16 v46, v115, v72
    v_dot2c_f32_bf16 v47, v115, v73
    v_dot2c_f32_bf16 v48, v116, v72
    v_dot2c_f32_bf16 v49, v116, v73
    v_dot2c_f32_bf16 v50, v117, v72
    v_dot2c_f32_bf16 v51, v117, v73
    v_dot2c_f32_bf16 v52, v118, v72
    v_dot2c_f32_bf16 v53, v118, v73
    v_dot2c_f32_bf16 v54, v119, v72
    v_dot2c_f32_bf16 v55, v119, v73
    v_permlane32_swap_b32 v32, v36
    v_permlane32_swap_b32 v33, v37
    v_permlane32_swap_b32 v34, v38
    v_permlane32_swap_b32 v35, v39
    v_permlane32_swap_b32 v40, v44
    v_permlane32_swap_b32 v41, v45
    v_permlane32_swap_b32 v42, v46
    v_permlane32_swap_b32 v43, v47
    v_permlane32_swap_b32 v48, v52
    v_permlane32_swap_b32 v49, v53
    v_permlane32_swap_b32 v50, v54
    v_permlane32_swap_b32 v51, v55
    v_pk_add_f32 v[32:33], v[32:33], v[36:37]
    v_pk_add_f32 v[34:35], v[34:35], v[38:39]
    v_pk_add_f32 v[40:41], v[40:41], v[44:45]
    v_pk_add_f32 v[42:43], v[42:43], v[46:47]
    v_pk_add_f32 v[48:49], v[48:49], v[52:53]
    v_pk_add_f32 v[50:51], v[50:51], v[54:55]
    v_permlane16_swap_b32 v32, v34
    v_permlane16_swap_b32 v33, v35
    v_permlane16_swap_b32 v40, v42
    v_permlane16_swap_b32 v41, v43
    v_permlane16_swap_b32 v48, v50
    v_permlane16_swap_b32 v49, v51
    v_pk_add_f32 v[32:33], v[32:33], v[34:35]
    v_pk_add_f32 v[40:41], v[40:41], v[42:43]
    v_pk_add_f32 v[48:49], v[48:49], v[50:51]
    v_add_f32_dpp v68, v32, v32 row_ror:8 row_mask:0xf bank_mask:0x3
    v_add_f32_dpp v69, v40, v40 row_ror:8 row_mask:0xf bank_mask:0x3
    v_add_f32_dpp v70, v48, v48 row_ror:8 row_mask:0xf bank_mask:0x3
    v_add_f32_dpp v68, v33, v33 row_ror:8 row_mask:0xf bank_mask:0xc
    v_add_f32_dpp v69, v41, v41 row_ror:8 row_mask:0xf bank_mask:0xc
    v_add_f32_dpp v70, v49, v49 row_ror:8 row_mask:0xf bank_mask:0xc
    ds_write_b32 v8, v68 offset:0
    ds_write_b32 v9, v69 offset:0
    ds_write_b32 v10, v70 offset:0
    buffer_load_dwordx4 v[148:151], v4, s[32:35], s64 offen offset:256 nt
    s_add_u32 s64, s64, 196608
    buffer_load_dwordx4 v[152:155], v4, s[28:31], s64 offen offset:0 nt
    buffer_load_dwordx4 v[156:159], v4, s[28:31], s64 offen offset:128 nt
    s_waitcnt lgkmcnt(0)
    s_barrier
    s_cmp_lg_u32 s56, 0
    s_cbranch_scc1 L_p1_done
    v_lshlrev_b32 v14, 4, v1
    ds_read_b128 v[32:35], v14 offset:0
    ds_read_b128 v[36:39], v14 offset:1024
    ds_read_b128 v[40:43], v14 offset:2048
    ds_read_b128 v[44:47], v14 offset:3072
    ds_read_b128 v[48:51], v14 offset:4096
    ds_read_b128 v[52:55], v14 offset:5120
    ds_read_b128 v[68:71], v14 offset:6144
    ds_read_b128 v[72:75], v14 offset:7168
    s_mul_i32 s78, s60, 5
    s_add_u32 s78, s78, s59
    s_lshl_b32 s78, s78, 10
    s_add_u32 s78, s78, 65536
    s_waitcnt lgkmcnt(0)
    v_add_f32 v32, v32, v36
    v_add_f32 v33, v33, v37
    v_add_f32 v34, v34, v38
    v_add_f32 v40, v40, v44
    v_add_f32 v41, v41, v45
    v_add_f32 v42, v42, v46
    v_add_f32 v48, v48, v52
    v_add_f32 v49, v49, v53
    v_add_f32 v50, v50, v54
    v_add_f32 v68, v68, v72
    v_add_f32 v69, v69, v73
    v_add_f32 v70, v70, v74
    v_add_f32 v32, v32, v40
    v_add_f32 v33, v33, v41
    v_add_f32 v34, v34, v42
    v_add_f32 v48, v48, v68
    v_add_f32 v49, v49, v69
    v_add_f32 v50, v50, v70
    v_add_f32 v32, v32, v48
    v_add_f32 v33, v33, v49
    v_add_f32 v34, v34, v50
    v_mov_b32 v35, v7
    buffer_store_dwordx4 v[32:35], v14, s[44:47], s78 offen sc1
L_p1_done:
    s_branch L_join1
L_noP1:
    buffer_load_dwordx4 v[128:131], v4, s[28:31], s64 offen offset:0 nt
    buffer_load_dwordx4 v[132:135], v4, s[28:31], s64 offen offset:128 nt
    buffer_load_dwordx4 v[136:139], v4, s[28:31], s64 offen offset:256 nt
    buffer_load_dwordx4 v[140:143], v4, s[32:35], s64 offen offset:0 nt
    buffer_load_dwordx4 v[144:147], v4, s[32:35], s64 offen offset:128 nt
    buffer_load_dwordx4 v[148:151], v4, s[32:35], s64 offen offset:256 nt
    s_add_u32 s64, s64, 196608
    buffer_load_dwordx4 v[152:155], v4, s[28:31], s64 offen offset:0 nt
    buffer_load_dwordx4 v[156:159], v4, s[28:31], s64 offen offset:128 nt
    s_mov_b32 s67, 0x3fb8aa3b
    s_mov_b32 s68, 0x3d93cd3a
    s_mov_b32 s73, 0x05040100
    s_mov_b32 s74, 0x07060302
    s_mov_b32 s52, s22
    s_and_b32 s53, s23, 0xffff
    s_mov_b32 s54, 1280
    s_mov_b32 s55, 0x00020000
    s_mov_b32 s40, s12
    s_and_b32 s41, s13, 0xffff
    s_mov_b32 s42, 0
    s_mov_b32 s43, 0x00020000
    s_mov_b32 s63, 0
    v_and_b32 v24, 15, v1
    v_lshlrev_b32 v24, 4, v24
    v_mul_u32_u24 v6, 3840, v2
    v_add_u32 v6, v6, v24
    v_xor_b32 v224, 1, v2
    v_mul_u32_u24 v224, 3840, v224
    v_add_u32 v224, v224, v24
    v_mov_b32 v226, v24
    v_xor_b32 v227, 1, v2
    s_lshl_b32 s78, s56, 10
    v_lshl_add_u32 v228, v1, 4, s78
    s_mov_b32 s75, 0
    s_mov_b32 s76, 0
    v_lshrrev_b32 v225, 4, v1
    v_lshlrev_b32 v225, 3, v225
    v_lshl_add_u32 v225, v24, 1, v225
    s_lshl_b32 s78, s56, 9
    v_add_u32 v225, s78, v225
    s_lshl_b32 s78, s56, 10
    v_lshl_add_u32 v24, v3, 3, v2
    v_add_u32 v25, 0, v24
    v_mul_u32_u24 v26, 21846, v25
    v_lshrrev_b32 v26, 16, v26
    v_add_u32 v25, v25, v26
    v_lshl_add_u32 v8, v25, 2, s78
    v_add_u32 v25, 64, v24
    v_mul_u32_u24 v26, 21846, v25
    v_lshrrev_b32 v26, 16, v26
    v_add_u32 v25, v25, v26
    v_lshl_add_u32 v9, v25, 2, s78
    v_add_u32 v25, 128, v24
    v_mul_u32_u24 v26, 21846, v25
    v_lshrrev_b32 v26, 16, v26
    v_add_u32 v25, v25, v26
    v_lshl_add_u32 v10, v25, 2, s78
    v_mov_b32 v11, 0xf149f2ca
    v_mov_b32 v12, 0
    s_waitcnt lgkmcnt(0)
    s_xor_b32 s65, s66, 0x5b3d1f37
    v_mov_b32 v7, s65
L_join1:
    s_mul_i32 s78, s57, 5120
    s_add_u32 s78, s78, 65536
    v_min_u32 v80, 39, v1
    s_mul_i32 s79, s56, 40
    v_add_u32 v80, s79, v80
    v_lshlrev_b32 v80, 4, v80
    v_add_u32 v81, s78, v80
    s_mov_b32 s69, 0
    s_waitcnt vmcnt(4)
    buffer_load_dwordx4 v[160:163], v4, s[28:31], s64 offen offset:256 nt
    s_cmp_lg_u32 s69, 0
    s_cbranch_scc1 L_nopoll1
    buffer_load_dwordx4 v[76:79], v81, s[44:47], 0 offen sc1
L_nopoll1:
    s_waitcnt vmcnt(4)
    buffer_load_dwordx4 v[164:167], v4, s[32:35], s64 offen offset:0 nt
    s_waitcnt vmcnt(4)
    buffer_load_dwordx4 v[168:171], v4, s[32:35], s64 offen offset:128 nt
    s_waitcnt vmcnt(4)
    buffer_load_dwordx4 v[172:175], v4, s[32:35], s64 offen offset:256 nt
    s_add_u32 s64, s64, 196608
    s_cmp_lg_u32 s69, 0
    s_cbranch_scc1 L_nochk1
    s_waitcnt vmcnt(3)
    v_cmp_ne_u32 vcc, s65, v79
    s_cbranch_vccnz L_nochk1
    ds_write_b128 v80, v[76:79] offset:16384
    s_mov_b32 s69, 1
L_nochk1:
    s_cmp_lg_u32 s69, 0
    s_cbranch_scc1 L_nopoll2
    buffer_load_dwordx4 v[76:79], v81, s[44:47], 0 offen sc1
L_nopoll2:
    s_waitcnt vmcnt(4)
    buffer_load_dwordx4 v[176:179], v4, s[28:31], s64 offen offset:0 nt
    s_waitcnt vmcnt(4)
    buffer_load_dwordx4 v[180:183], v4, s[28:31], s64 offen offset:128 nt
    s_waitcnt vmcnt(4)
    buffer_load_dwordx4 v[184:187], v4, s[28:31], s64 offen offset:256 nt
    s_cmp_lg_u32 s69, 0
    s_cbranch_scc1 L_nochk2
    s_waitcnt vmcnt(3)
    v_cmp_ne_u32 vcc, s65, v79
    s_cbranch_vccnz L_nochk2
    ds_write_b128 v80, v[76:79] offset:16384
    s_mov_b32 s69, 1
L_nochk2:
    s_cmp_lg_u32 s69, 0
    s_cbranch_scc1 L_poll_q_done
    s_mov_b32 s78, 0
L_poll_q:
    buffer_load_dwordx4 v[76:79], v81, s[44:47], 0 offen sc1
    s_waitcnt vmcnt(0)
    v_cmp_ne_u32 vcc, s65, v79
    s_cbranch_vccz L_poll_q_ok
    s_add_u32 s78, s78, 1
    s_cmp_lt_u32 s78, 20000
    s_cbranch_scc1 L_poll_q
L_poll_q_ok:
    ds_write_b128 v80, v[76:79] offset:16384
L_poll_q_done:
    v_mov_b32 v123, 0
    ds_write_b32 v123, v123 offset:28744
    ds_write_b32 v123, v123 offset:28736
    ds_write_b32 v123, v123 offset:28752
    ds_write_b32 v123, v123 offset:28756
    buffer_load_dwordx4 v[188:191], v4, s[32:35], s64 offen offset:0 nt
    buffer_load_dwordx4 v[192:195], v4, s[32:35], s64 offen offset:128 nt
    buffer_load_dwordx4 v[196:199], v4, s[32:35], s64 offen offset:256 nt
    s_add_u32 s64, s64, 196608
    s_waitcnt lgkmcnt(0)
    s_barrier
    v_lshlrev_b32 v14, 4, v1
    ds_read_b128 v[68:71], v14 offset:16384
    ds_read_b128 v[72:75], v14 offset:17408
    ds_read_b128 v[76:79], v14 offset:18432
    ds_read_b128 v[80:83], v14 offset:19456
    ds_read_b128 v[84:87], v14 offset:20480
    s_lshl_b32 s78, s56, 9
    s_add_u32 s78, s78, 24576
    v_mul_u32_u24 v15, 6, v1
    v_add_u32 v15, s78, v15
    v_lshl_add_u32 v16, v3, 4, s78
    s_waitcnt lgkmcnt(0)
    v_add_f32 v68, v68, v72
    v_add_f32 v76, v76, v80
    v_add_f32 v69, v69, v73
    v_add_f32 v77, v77, v81
    v_add_f32 v70, v70, v74
    v_add_f32 v78, v78, v82
    v_add_f32 v68, v68, v84
    v_add_f32 v69, v69, v85
    v_add_f32 v70, v70, v86
    v_add_f32 v68, v68, v76
    v_add_f32 v69, v69, v77
    v_add_f32 v70, v70, v78
    v_cvt_pk_bf16_f32 v72, v68, v69
    v_cvt_pk_bf16_f32 v73, v70, v70
    ds_write_b16 v15, v72
    ds_write_b16_d16_hi v15, v72 offset:2
    ds_write_b16 v15, v73 offset:4
    s_waitcnt lgkmcnt(0)
    ds_read_b128 v[56:59], v16 offset:0
    ds_read_b128 v[60:63], v16 offset:128
    ds_read_b128 v[64:67], v16 offset:256
    v_mov_b32 v32, 0
    v_mov_b32 v33, 0
    v_mov_b32 v34, 0
    v_mov_b32 v35, 0
    v_mov_b32 v36, 0
    v_mov_b32 v37, 0
    v_mov_b32 v38, 0
    v_mov_b32 v39, 0
    v_mov_b32 v40, 0
    v_mov_b32 v41, 0
    v_mov_b32 v42, 0
    v_mov_b32 v43, 0
    v_mov_b32 v44, 0
    v_mov_b32 v45, 0
    v_mov_b32 v46, 0
    v_mov_b32 v47, 0
    v_mov_b32 v48, 0
    v_mov_b32 v49, 0
    v_mov_b32 v50, 0
    v_mov_b32 v51, 0
    v_mov_b32 v52, 0
    v_mov_b32 v53, 0
    v_mov_b32 v54, 0
    v_mov_b32 v55, 0
    s_waitcnt lgkmcnt(0)
    s_mov_b32 s36, s24
    s_and_b32 s37, s25, 0xffff
    s_mov_b32 s38, 256
    s_mov_b32 s39, 0x00020000
    s_and_b32 s61, s2, 3
    s_lshl_b32 s61, s61, 6
    v_dot2_f32_bf16 v68, v128, v56, 0
    v_dot2_f32_bf16 v69, v129, v57, 0
    v_dot2_f32_bf16 v70, v130, v58, 0
    v_dot2_f32_bf16 v71, v131, v59, 0
    v_dot2c_f32_bf16 v68, v132, v60
    v_dot2c_f32_bf16 v69, v133, v61
    v_dot2c_f32_bf16 v70, v134, v62
    v_dot2c_f32_bf16 v71, v135, v63
    v_dot2c_f32_bf16 v68, v136, v64
    v_dot2c_f32_bf16 v69, v137, v65
    v_dot2c_f32_bf16 v70, v138, v66
    v_dot2c_f32_bf16 v71, v139, v67
    s_nop 0
    v_add_f32 v68, v68, v69
    s_nop 0
    v_add_f32 v70, v70, v71
    v_add_f32 v72, v68, v70
    s_nop 1
    v_add_f32_dpp v72, v72, v72 quad_perm:[1,0,3,2] row_mask:0xf bank_mask:0xf
    s_nop 1
    v_add_f32_dpp v72, v72, v72 quad_perm:[2,3,0,1] row_mask:0xf bank_mask:0xf
    s_nop 1
    v_add_f32_dpp v72, v72, v72 row_half_mirror row_mask:0xf bank_mask:0xf
    v_cvt_pk_bf16_f32 v72, 0, v72
    v_mul_f32 v72, s68, v72
    v_cvt_pk_bf16_f32 v72, 0, v72
    v_max_f32 v73, v11, v72
    v_sub_f32 v74, v11, v73
    v_sub_f32 v76, v72, v73
    v_mul_f32 v74, s67, v74
    v_mul_f32 v76, s67, v76
    v_exp_f32 v74, v74
    v_exp_f32 v76, v76
    v_mov_b32 v11, v73
    v_fma_f32 v12, v12, v74, v76
    v_cvt_pk_bf16_f32 v120, v76, 0
    v_cvt_pk_bf16_f32 v121, 0, v76
    v_pk_mul_f32 v[32:33], v[32:33], v[74:75] op_sel_hi:[1,0]
    v_pk_mul_f32 v[34:35], v[34:35], v[74:75] op_sel_hi:[1,0]
    v_pk_mul_f32 v[36:37], v[36:37], v[74:75] op_sel_hi:[1,0]
    v_pk_mul_f32 v[38:39], v[38:39], v[74:75] op_sel_hi:[1,0]
    v_pk_mul_f32 v[40:41], v[40:41], v[74:75] op_sel_hi:[1,0]
    v_pk_mul_f32 v[42:43], v[42:43], v[74:75] op_sel_hi:[1,0]
    v_pk_mul_f32 v[44:45], v[44:45], v[74:75] op_sel_hi:[1,0]
    v_pk_mul_f32 v[46:47], v[46:47], v[74:75] op_sel_hi:[1,0]
    v_pk_mul_f32 v[48:49], v[48:49], v[74:75] op_sel_hi:[1,0]
    v_pk_mul_f32 v[50:51], v[50:51], v[74:75] op_sel_hi:[1,0]
    v_pk_mul_f32 v[52:53], v[52:53], v[74:75] op_sel_hi:[1,0]
    v_pk_mul_f32 v[54:55], v[54:55], v[74:75] op_sel_hi:[1,0]
    v_dot2c_f32_bf16 v32, v140, v120
    v_dot2c_f32_bf16 v33, v140, v121
    v_dot2c_f32_bf16 v34, v141, v120
    v_dot2c_f32_bf16 v35, v141, v121
    v_dot2c_f32_bf16 v36, v142, v120
    v_dot2c_f32_bf16 v37, v142, v121
    v_dot2c_f32_bf16 v38, v143, v120
    v_dot2c_f32_bf16 v39, v143, v121
    v_dot2c_f32_bf16 v40, v144, v120
    v_dot2c_f32_bf16 v41, v144, v121
    v_dot2c_f32_bf16 v42, v145, v120
    v_dot2c_f32_bf16 v43, v145, v121
    v_dot2c_f32_bf16 v44, v146, v120
    v_dot2c_f32_bf16 v45, v146, v121
    v_dot2c_f32_bf16 v46, v147, v120
    v_dot2c_f32_bf16 v47, v147, v121
    v_dot2c_f32_bf16 v48, v148, v120
    v_dot2c_f32_bf16 v49, v148, v121
    v_dot2c_f32_bf16 v50, v149, v120
    v_dot2c_f32_bf16 v51, v149, v121
    v_dot2c_f32_bf16 v52, v150, v120
    v_dot2c_f32_bf16 v53, v150, v121
    v_dot2c_f32_bf16 v54, v151, v120
    v_dot2c_f32_bf16 v55, v151, v121
    s_waitcnt vmcnt(3)
    v_mov_b32 v13, 1
    s_mov_b64 exec, 1
    buffer_atomic_add v13, off, s[44:47], s93 sc0
    s_mov_b64 exec, -1
    buffer_load_dwordx4 v[128:131], v4, s[28:31], s64 offen offset:0 nt
    buffer_load_dwordx4 v[132:135], v4, s[28:31], s64 offen offset:128 nt
    buffer_load_dwordx4 v[136:139], v4, s[28:31], s64 offen offset:256 nt
    v_dot2_f32_bf16 v68, v152, v56, 0
    v_dot2_f32_bf16 v69, v153, v57, 0
    v_dot2_f32_bf16 v70, v154, v58, 0
    v_dot2_f32_bf16 v71, v155, v59, 0
    v_dot2c_f32_bf16 v68, v156, v60
    v_dot2c_f32_bf16 v69, v157, v61
    v_dot2c_f32_bf16 v70, v158, v62
    v_dot2c_f32_bf16 v71, v159, v63
    v_dot2c_f32_bf16 v68, v160, v64
    v_dot2c_f32_bf16 v69, v161, v65
    v_dot2c_f32_bf16 v70, v162, v66
    v_dot2c_f32_bf16 v71, v163, v67
    s_nop 0
    v_add_f32 v68, v68, v69
    s_nop 0
    v_add_f32 v70, v70, v71
    v_add_f32 v72, v68, v70
    s_nop 1
    v_add_f32_dpp v72, v72, v72 quad_perm:[1,0,3,2] row_mask:0xf bank_mask:0xf
    s_nop 1
    v_add_f32_dpp v72, v72, v72 quad_perm:[2,3,0,1] row_mask:0xf bank_mask:0xf
    s_nop 1
    v_add_f32_dpp v72, v72, v72 row_half_mirror row_mask:0xf bank_mask:0xf
    v_cvt_pk_bf16_f32 v72, 0, v72
    v_mul_f32 v72, s68, v72
    v_cvt_pk_bf16_f32 v72, 0, v72
    v_max_f32 v73, v11, v72
    v_sub_f32 v74, v11, v73
    v_sub_f32 v76, v72, v73
    v_mul_f32 v74, s67, v74
    v_mul_f32 v76, s67, v76
    v_exp_f32 v74, v74
    v_exp_f32 v76, v76
    v_mov_b32 v11, v73
    v_fma_f32 v12, v12, v74, v76
    v_cvt_pk_bf16_f32 v120, v76, 0
    v_cvt_pk_bf16_f32 v121, 0, v76
    v_pk_mul_f32 v[32:33], v[32:33], v[74:75] op_sel_hi:[1,0]
    v_pk_mul_f32 v[34:35], v[34:35], v[74:75] op_sel_hi:[1,0]
    v_pk_mul_f32 v[36:37], v[36:37], v[74:75] op_sel_hi:[1,0]
    v_pk_mul_f32 v[38:39], v[38:39], v[74:75] op_sel_hi:[1,0]
    v_pk_mul_f32 v[40:41], v[40:41], v[74:75] op_sel_hi:[1,0]
    v_pk_mul_f32 v[42:43], v[42:43], v[74:75] op_sel_hi:[1,0]
    v_pk_mul_f32 v[44:45], v[44:45], v[74:75] op_sel_hi:[1,0]
    v_pk_mul_f32 v[46:47], v[46:47], v[74:75] op_sel_hi:[1,0]
    v_pk_mul_f32 v[48:49], v[48:49], v[74:75] op_sel_hi:[1,0]
    v_pk_mul_f32 v[50:51], v[50:51], v[74:75] op_sel_hi:[1,0]
    v_pk_mul_f32 v[52:53], v[52:53], v[74:75] op_sel_hi:[1,0]
    v_pk_mul_f32 v[54:55], v[54:55], v[74:75] op_sel_hi:[1,0]
    v_dot2c_f32_bf16 v32, v164, v120
    v_dot2c_f32_bf16 v33, v164, v121
    v_dot2c_f32_bf16 v34, v165, v120
    v_dot2c_f32_bf16 v35, v165, v121
    v_dot2c_f32_bf16 v36, v166, v120
    v_dot2c_f32_bf16 v37, v166, v121
    v_dot2c_f32_bf16 v38, v167, v120
    v_dot2c_f32_bf16 v39, v167, v121
    v_dot2c_f32_bf16 v40, v168, v120
    v_dot2c_f32_bf16 v41, v168, v121
    v_dot2c_f32_bf16 v42, v169, v120
    v_dot2c_f32_bf16 v43, v169, v121
    v_dot2c_f32_bf16 v44, v170, v120
    v_dot2c_f32_bf16 v45, v170, v121
    v_dot2c_f32_bf16 v46, v171, v120
    v_dot2c_f32_bf16 v47, v171, v121
    v_dot2c_f32_bf16 v48, v172, v120
    v_dot2c_f32_bf16 v49, v172, v121
    v_dot2c_f32_bf16 v50, v173, v120
    v_dot2c_f32_bf16 v51, v173, v121
    v_dot2c_f32_bf16 v52, v174, v120
    v_dot2c_f32_bf16 v53, v174, v121
    v_dot2c_f32_bf16 v54, v175, v120
    v_dot2c_f32_bf16 v55, v175, v121
    v_dot2_f32_bf16 v68, v176, v56, 0
    v_dot2_f32_bf16 v69, v177, v57, 0
    v_dot2_f32_bf16 v70, v178, v58, 0
    v_dot2_f32_bf16 v71, v179, v59, 0
    v_dot2c_f32_bf16 v68, v180, v60
    v_dot2c_f32_bf16 v69, v181, v61
    v_dot2c_f32_bf16 v70, v182, v62
    v_dot2c_f32_bf16 v71, v183, v63
    v_dot2c_f32_bf16 v68, v184, v64
    v_dot2c_f32_bf16 v69, v185, v65
    v_dot2c_f32_bf16 v70, v186, v66
    v_dot2c_f32_bf16 v71, v187, v67
    s_nop 0
    v_add_f32 v68, v68, v69
    s_nop 0
    v_add_f32 v70, v70, v71
    v_add_f32 v72, v68, v70
    s_nop 1
    v_add_f32_dpp v72, v72, v72 quad_perm:[1,0,3,2] row_mask:0xf bank_mask:0xf
    s_nop 1
    v_add_f32_dpp v72, v72, v72 quad_perm:[2,3,0,1] row_mask:0xf bank_mask:0xf
    s_nop 1
    v_add_f32_dpp v72, v72, v72 row_half_mirror row_mask:0xf bank_mask:0xf
    v_cvt_pk_bf16_f32 v72, 0, v72
    v_mul_f32 v72, s68, v72
    v_cvt_pk_bf16_f32 v72, 0, v72
    v_max_f32 v73, v11, v72
    v_sub_f32 v74, v11, v73
    v_sub_f32 v76, v72, v73
    v_mul_f32 v74, s67, v74
    v_mul_f32 v76, s67, v76
    v_exp_f32 v74, v74
    v_exp_f32 v76, v76
    v_mov_b32 v11, v73
    v_fma_f32 v12, v12, v74, v76
    v_cvt_pk_bf16_f32 v120, v76, 0
    v_cvt_pk_bf16_f32 v121, 0, v76
    v_pk_mul_f32 v[32:33], v[32:33], v[74:75] op_sel_hi:[1,0]
    v_pk_mul_f32 v[34:35], v[34:35], v[74:75] op_sel_hi:[1,0]
    v_pk_mul_f32 v[36:37], v[36:37], v[74:75] op_sel_hi:[1,0]
    v_pk_mul_f32 v[38:39], v[38:39], v[74:75] op_sel_hi:[1,0]
    v_pk_mul_f32 v[40:41], v[40:41], v[74:75] op_sel_hi:[1,0]
    v_pk_mul_f32 v[42:43], v[42:43], v[74:75] op_sel_hi:[1,0]
    v_pk_mul_f32 v[44:45], v[44:45], v[74:75] op_sel_hi:[1,0]
    v_pk_mul_f32 v[46:47], v[46:47], v[74:75] op_sel_hi:[1,0]
    v_pk_mul_f32 v[48:49], v[48:49], v[74:75] op_sel_hi:[1,0]
    v_pk_mul_f32 v[50:51], v[50:51], v[74:75] op_sel_hi:[1,0]
    v_pk_mul_f32 v[52:53], v[52:53], v[74:75] op_sel_hi:[1,0]
    v_pk_mul_f32 v[54:55], v[54:55], v[74:75] op_sel_hi:[1,0]
    s_waitcnt vmcnt(3)
    buffer_load_dwordx4 v[140:143], v4, s[32:35], s64 offen offset:0 nt
    buffer_load_dwordx4 v[144:147], v4, s[32:35], s64 offen offset:128 nt
    buffer_load_dwordx4 v[148:151], v4, s[32:35], s64 offen offset:256 nt
    s_add_u32 s64, s64, 196608
    v_dot2c_f32_bf16 v32, v188, v120
    v_dot2c_f32_bf16 v33, v188, v121
    v_dot2c_f32_bf16 v34, v189, v120
    v_dot2c_f32_bf16 v35, v189, v121
    v_dot2c_f32_bf16 v36, v190, v120
    v_dot2c_f32_bf16 v37, v190, v121
    v_dot2c_f32_bf16 v38, v191, v120
    v_dot2c_f32_bf16 v39, v191, v121
    v_dot2c_f32_bf16 v40, v192, v120
    v_dot2c_f32_bf16 v41, v192, v121
    v_dot2c_f32_bf16 v42, v193, v120
    v_dot2c_f32_bf16 v43, v193, v121
    v_dot2c_f32_bf16 v44, v194, v120
    v_dot2c_f32_bf16 v45, v194, v121
    v_dot2c_f32_bf16 v46, v195, v120
    v_dot2c_f32_bf16 v47, v195, v121
    v_dot2c_f32_bf16 v48, v196, v120
    v_dot2c_f32_bf16 v49, v196, v121
    v_dot2c_f32_bf16 v50, v197, v120
    v_dot2c_f32_bf16 v51, v197, v121
    v_dot2c_f32_bf16 v52, v198, v120
    v_dot2c_f32_bf16 v53, v198, v121
    v_dot2c_f32_bf16 v54, v199, v120
    v_dot2c_f32_bf16 v55, v199, v121
L_loop:
    s_waitcnt vmcnt(3)
    v_readfirstlane_b32 s94, v13
    s_cmp_ge_u32 s94, 512
    s_cbranch_scc1 L_exitA
    s_mul_i32 s94, s94, 3072
    v_mov_b32 v13, 1
    s_mov_b64 exec, 1
    buffer_atomic_add v13, off, s[44:47], s93 sc0
    s_mov_b64 exec, -1
    buffer_load_dwordx4 v[176:179], v4, s[28:31], s94 offen offset:0 nt
    buffer_load_dwordx4 v[180:183], v4, s[28:31], s94 offen offset:128 nt
    buffer_load_dwordx4 v[184:187], v4, s[28:31], s94 offen offset:256 nt
    v_dot2_f32_bf16 v68, v128, v56, 0
    v_dot2_f32_bf16 v69, v129, v57, 0
    v_dot2_f32_bf16 v70, v130, v58, 0
    v_dot2_f32_bf16 v71, v131, v59, 0
    v_dot2c_f32_bf16 v68, v132, v60
    v_dot2c_f32_bf16 v69, v133, v61
    v_dot2c_f32_bf16 v70, v134, v62
    v_dot2c_f32_bf16 v71, v135, v63
    v_dot2c_f32_bf16 v68, v136, v64
    v_dot2c_f32_bf16 v69, v137, v65
    v_dot2c_f32_bf16 v70, v138, v66
    v_dot2c_f32_bf16 v71, v139, v67
    s_nop 0
    v_add_f32 v68, v68, v69
    s_nop 0
    v_add_f32 v70, v70, v71
    v_add_f32 v72, v68, v70
    s_nop 1
    v_add_f32_dpp v72, v72, v72 quad_perm:[1,0,3,2] row_mask:0xf bank_mask:0xf
    s_nop 1
    v_add_f32_dpp v72, v72, v72 quad_perm:[2,3,0,1] row_mask:0xf bank_mask:0xf
    s_nop 1
    v_add_f32_dpp v72, v72, v72 row_half_mirror row_mask:0xf bank_mask:0xf
    v_cvt_pk_bf16_f32 v72, 0, v72
    v_mul_f32 v72, s68, v72
    v_cvt_pk_bf16_f32 v72, 0, v72
    v_max_f32 v73, v11, v72
    v_sub_f32 v74, v11, v73
    v_sub_f32 v76, v72, v73
    v_mul_f32 v74, s67, v74
    v_mul_f32 v76, s67, v76
    v_exp_f32 v74, v74
    v_exp_f32 v76, v76
    v_mov_b32 v11, v73
    v_fma_f32 v12, v12, v74, v76
    v_cvt_pk_bf16_f32 v120, v76, 0
    v_cvt_pk_bf16_f32 v121, 0, v76
    v_pk_mul_f32 v[32:33], v[32:33], v[74:75] op_sel_hi:[1,0]
    v_pk_mul_f32 v[34:35], v[34:35], v[74:75] op_sel_hi:[1,0]
    v_pk_mul_f32 v[36:37], v[36:37], v[74:75] op_sel_hi:[1,0]
    v_pk_mul_f32 v[38:39], v[38:39], v[74:75] op_sel_hi:[1,0]
    v_pk_mul_f32 v[40:41], v[40:41], v[74:75] op_sel_hi:[1,0]
    v_pk_mul_f32 v[42:43], v[42:43], v[74:75] op_sel_hi:[1,0]
    v_pk_mul_f32 v[44:45], v[44:45], v[74:75] op_sel_hi:[1,0]
    v_pk_mul_f32 v[46:47], v[46:47], v[74:75] op_sel_hi:[1,0]
    v_pk_mul_f32 v[48:49], v[48:49], v[74:75] op_sel_hi:[1,0]
    v_pk_mul_f32 v[50:51], v[50:51], v[74:75] op_sel_hi:[1,0]
    v_pk_mul_f32 v[52:53], v[52:53], v[74:75] op_sel_hi:[1,0]
    v_pk_mul_f32 v[54:55], v[54:55], v[74:75] op_sel_hi:[1,0]
    s_waitcnt vmcnt(4)
    buffer_load_dwordx4 v[188:191], v4, s[32:35], s94 offen offset:0 nt
    buffer_load_dwordx4 v[192:195], v4, s[32:35], s94 offen offset:128 nt
    buffer_load_dwordx4 v[196:199], v4, s[32:35], s94 offen offset:256 nt
    v_dot2c_f32_bf16 v32, v140, v120
    v_dot2c_f32_bf16 v33, v140, v121
    v_dot2c_f32_bf16 v34, v141, v120
    v_dot2c_f32_bf16 v35, v141, v121
    v_dot2c_f32_bf16 v36, v142, v120
    v_dot2c_f32_bf16 v37, v142, v121
    v_dot2c_f32_bf16 v38, v143, v120
    v_dot2c_f32_bf16 v39, v143, v121
    v_dot2c_f32_bf16 v40, v144, v120
    v_dot2c_f32_bf16 v41, v144, v121
    v_dot2c_f32_bf16 v42, v145, v120
    v_dot2c_f32_bf16 v43, v145, v121
    v_dot2c_f32_bf16 v44, v146, v120
    v_dot2c_f32_bf16 v45, v146, v121
    v_dot2c_f32_bf16 v46, v147, v120
    v_dot2c_f32_bf16 v47, v147, v121
    v_dot2c_f32_bf16 v48, v148, v120
    v_dot2c_f32_bf16 v49, v148, v121
    v_dot2c_f32_bf16 v50, v149, v120
    v_dot2c_f32_bf16 v51, v149, v121
    v_dot2c_f32_bf16 v52, v150, v120
    v_dot2c_f32_bf16 v53, v150, v121
    v_dot2c_f32_bf16 v54, v151, v120
    v_dot2c_f32_bf16 v55, v151, v121
    s_waitcnt vmcnt(3)
    v_readfirstlane_b32 s94, v13
    s_cmp_ge_u32 s94, 512
    s_cbranch_scc1 L_exitB
    s_mul_i32 s94, s94, 3072
    v_mov_b32 v13, 1
    s_mov_b64 exec, 1
    buffer_atomic_add v13, off, s[44:47], s93 sc0
    s_mov_b64 exec, -1
    buffer_load_dwordx4 v[128:131], v4, s[28:31], s94 offen offset:0 nt
    buffer_load_dwordx4 v[132:135], v4, s[28:31], s94 offen offset:128 nt
    buffer_load_dwordx4 v[136:139], v4, s[28:31], s94 offen offset:256 nt
    v_dot2_f32_bf16 v68, v176, v56, 0
    v_dot2_f32_bf16 v69, v177, v57, 0
    v_dot2_f32_bf16 v70, v178, v58, 0
    v_dot2_f32_bf16 v71, v179, v59, 0
    v_dot2c_f32_bf16 v68, v180, v60
    v_dot2c_f32_bf16 v69, v181, v61
    v_dot2c_f32_bf16 v70, v182, v62
    v_dot2c_f32_bf16 v71, v183, v63
    v_dot2c_f32_bf16 v68, v184, v64
    v_dot2c_f32_bf16 v69, v185, v65
    v_dot2c_f32_bf16 v70, v186, v66
    v_dot2c_f32_bf16 v71, v187, v67
    s_nop 0
    v_add_f32 v68, v68, v69
    s_nop 0
    v_add_f32 v70, v70, v71
    v_add_f32 v72, v68, v70
    s_nop 1
    v_add_f32_dpp v72, v72, v72 quad_perm:[1,0,3,2] row_mask:0xf bank_mask:0xf
    s_nop 1
    v_add_f32_dpp v72, v72, v72 quad_perm:[2,3,0,1] row_mask:0xf bank_mask:0xf
    s_nop 1
    v_add_f32_dpp v72, v72, v72 row_half_mirror row_mask:0xf bank_mask:0xf
    v_cvt_pk_bf16_f32 v72, 0, v72
    v_mul_f32 v72, s68, v72
    v_cvt_pk_bf16_f32 v72, 0, v72
    v_max_f32 v73, v11, v72
    v_sub_f32 v74, v11, v73
    v_sub_f32 v76, v72, v73
    v_mul_f32 v74, s67, v74
    v_mul_f32 v76, s67, v76
    v_exp_f32 v74, v74
    v_exp_f32 v76, v76
    v_mov_b32 v11, v73
    v_fma_f32 v12, v12, v74, v76
    v_cvt_pk_bf16_f32 v120, v76, 0
    v_cvt_pk_bf16_f32 v121, 0, v76
    v_pk_mul_f32 v[32:33], v[32:33], v[74:75] op_sel_hi:[1,0]
    v_pk_mul_f32 v[34:35], v[34:35], v[74:75] op_sel_hi:[1,0]
    v_pk_mul_f32 v[36:37], v[36:37], v[74:75] op_sel_hi:[1,0]
    v_pk_mul_f32 v[38:39], v[38:39], v[74:75] op_sel_hi:[1,0]
    v_pk_mul_f32 v[40:41], v[40:41], v[74:75] op_sel_hi:[1,0]
    v_pk_mul_f32 v[42:43], v[42:43], v[74:75] op_sel_hi:[1,0]
    v_pk_mul_f32 v[44:45], v[44:45], v[74:75] op_sel_hi:[1,0]
    v_pk_mul_f32 v[46:47], v[46:47], v[74:75] op_sel_hi:[1,0]
    v_pk_mul_f32 v[48:49], v[48:49], v[74:75] op_sel_hi:[1,0]
    v_pk_mul_f32 v[50:51], v[50:51], v[74:75] op_sel_hi:[1,0]
    v_pk_mul_f32 v[52:53], v[52:53], v[74:75] op_sel_hi:[1,0]
    v_pk_mul_f32 v[54:55], v[54:55], v[74:75] op_sel_hi:[1,0]
    s_waitcnt vmcnt(4)
    buffer_load_dwordx4 v[140:143], v4, s[32:35], s94 offen offset:0 nt
    buffer_load_dwordx4 v[144:147], v4, s[32:35], s94 offen offset:128 nt
    buffer_load_dwordx4 v[148:151], v4, s[32:35], s94 offen offset:256 nt
    v_dot2c_f32_bf16 v32, v188, v120
    v_dot2c_f32_bf16 v33, v188, v121
    v_dot2c_f32_bf16 v34, v189, v120
    v_dot2c_f32_bf16 v35, v189, v121
    v_dot2c_f32_bf16 v36, v190, v120
    v_dot2c_f32_bf16 v37, v190, v121
    v_dot2c_f32_bf16 v38, v191, v120
    v_dot2c_f32_bf16 v39, v191, v121
    v_dot2c_f32_bf16 v40, v192, v120
    v_dot2c_f32_bf16 v41, v192, v121
    v_dot2c_f32_bf16 v42, v193, v120
    v_dot2c_f32_bf16 v43, v193, v121
    v_dot2c_f32_bf16 v44, v194, v120
    v_dot2c_f32_bf16 v45, v194, v121
    v_dot2c_f32_bf16 v46, v195, v120
    v_dot2c_f32_bf16 v47, v195, v121
    v_dot2c_f32_bf16 v48, v196, v120
    v_dot2c_f32_bf16 v49, v196, v121
    v_dot2c_f32_bf16 v50, v197, v120
    v_dot2c_f32_bf16 v51, v197, v121
    v_dot2c_f32_bf16 v52, v198, v120
    v_dot2c_f32_bf16 v53, v198, v121
    v_dot2c_f32_bf16 v54, v199, v120
    v_dot2c_f32_bf16 v55, v199, v121
    s_branch L_loop
L_exitA:
    v_mov_b32 v122, 1
    s_mov_b64 exec, 1
    ds_add_rtn_u32 v122, v123, v122 offset:28744
    s_mov_b64 exec, -1
    v_dot2_f32_bf16 v68, v128, v56, 0
    v_dot2_f32_bf16 v69, v129, v57, 0
    v_dot2_f32_bf16 v70, v130, v58, 0
    v_dot2_f32_bf16 v71, v131, v59, 0
    v_dot2c_f32_bf16 v68, v132, v60
    v_dot2c_f32_bf16 v69, v133, v61
    v_dot2c_f32_bf16 v70, v134, v62
    v_dot2c_f32_bf16 v71, v135, v63
    v_dot2c_f32_bf16 v68, v136, v64
    v_dot2c_f32_bf16 v69, v137, v65
    v_dot2c_f32_bf16 v70, v138, v66
    v_dot2c_f32_bf16 v71, v139, v67
    s_nop 0
    v_add_f32 v68, v68, v69
    s_nop 0
    v_add_f32 v70, v70, v71
    v_add_f32 v72, v68, v70
    s_nop 1
    v_add_f32_dpp v72, v72, v72 quad_perm:[1,0,3,2] row_mask:0xf bank_mask:0xf
    s_nop 1
    v_add_f32_dpp v72, v72, v72 quad_perm:[2,3,0,1] row_mask:0xf bank_mask:0xf
    s_nop 1
    v_add_f32_dpp v72, v72, v72 row_half_mirror row_mask:0xf bank_mask:0xf
    v_cvt_pk_bf16_f32 v72, 0, v72
    v_mul_f32 v72, s68, v72
    v_cvt_pk_bf16_f32 v72, 0, v72
    s_waitcnt lgkmcnt(0)
    v_readfirstlane_b32 s60, v122
    s_cmp_lg_u32 s60, 0
    s_cbranch_scc1 L_ndA
    v_mov_b32 v13, 1
    s_mov_b64 exec, 1
    buffer_atomic_add v13, off, s[36:39], s61 sc0
    s_mov_b64 exec, -1
L_ndA:
    v_max_f32 v68, v11, v72
    v_mov_b32 v70, v68
    s_nop 1
    v_permlane32_swap_b32 v68, v70
    v_max_f32 v68, v68, v70
    v_mov_b32 v70, v68
    s_nop 1
    v_permlane16_swap_b32 v68, v70
    v_max_f32 v68, v68, v70
    s_nop 1
    v_max_f32_dpp v68, v68, v68 row_ror:8 row_mask:0xf bank_mask:0xf
    v_sub_f32 v74, v11, v68
    v_sub_f32 v76, v72, v68
    v_mul_f32 v74, s67, v74
    v_mul_f32 v76, s67, v76
    v_exp_f32 v74, v74
    v_exp_f32 v76, v76
    s_lshl_b32 s78, s56, 3
    v_fma_f32 v12, v12, v74, v76
    v_cvt_pk_bf16_f32 v120, v76, 0
    v_cvt_pk_bf16_f32 v121, 0, v76
    v_mov_b32 v70, v12
    v_pk_mul_f32 v[54:55], v[54:55], v[74:75] op_sel_hi:[1,0]
    v_pk_mul_f32 v[52:53], v[52:53], v[74:75] op_sel_hi:[1,0]
    v_permlane32_swap_b32 v12, v70
    v_pk_mul_f32 v[50:51], v[50:51], v[74:75] op_sel_hi:[1,0]
    v_pk_mul_f32 v[48:49], v[48:49], v[74:75] op_sel_hi:[1,0]
    v_add_f32 v12, v12, v70
    v_mov_b32 v70, v12
    v_pk_mul_f32 v[46:47], v[46:47], v[74:75] op_sel_hi:[1,0]
    v_pk_mul_f32 v[44:45], v[44:45], v[74:75] op_sel_hi:[1,0]
    v_permlane16_swap_b32 v12, v70
    v_pk_mul_f32 v[42:43], v[42:43], v[74:75] op_sel_hi:[1,0]
    v_pk_mul_f32 v[40:41], v[40:41], v[74:75] op_sel_hi:[1,0]
    v_add_f32 v12, v12, v70
    v_pk_mul_f32 v[38:39], v[38:39], v[74:75] op_sel_hi:[1,0]
    v_pk_mul_f32 v[36:37], v[36:37], v[74:75] op_sel_hi:[1,0]
    v_add_f32_dpp v12, v12, v12 row_ror:8 row_mask:0xf bank_mask:0xf
    v_pk_mul_f32 v[34:35], v[34:35], v[74:75] op_sel_hi:[1,0]
    v_pk_mul_f32 v[32:33], v[32:33], v[74:75] op_sel_hi:[1,0]
    v_mov_b32 v70, s78
    v_mov_b32 v69, v12
    v_lshlrev_b32 v14, 4, v1
    v_mov_b32 v16, 1
    v_lshlrev_b32 v15, 3, v3
    s_mov_b64 exec, 1
    ds_write_b64 v70, v[68:69] offset:28672
    s_mov_b64 exec, -1
    s_cmp_lg_u32 s60, 0
    s_cbranch_scc1 L_w0A
    s_waitcnt vmcnt(1)
    s_branch L_drA
L_w0A:
    s_waitcnt vmcnt(0)
L_drA:
    v_dot2c_f32_bf16 v32, v140, v120
    v_dot2c_f32_bf16 v33, v140, v121
    v_dot2c_f32_bf16 v34, v141, v120
    v_dot2c_f32_bf16 v35, v141, v121
    v_dot2c_f32_bf16 v36, v142, v120
    v_dot2c_f32_bf16 v37, v142, v121
    v_dot2c_f32_bf16 v38, v143, v120
    v_dot2c_f32_bf16 v39, v143, v121
    v_dot2c_f32_bf16 v40, v144, v120
    v_dot2c_f32_bf16 v41, v144, v121
    v_dot2c_f32_bf16 v42, v145, v120
    v_dot2c_f32_bf16 v43, v145, v121
    v_dot2c_f32_bf16 v44, v146, v120
    v_dot2c_f32_bf16 v45, v146, v121
    v_dot2c_f32_bf16 v46, v147, v120
    v_dot2c_f32_bf16 v47, v147, v121
    v_dot2c_f32_bf16 v48, v148, v120
    v_dot2c_f32_bf16 v49, v148, v121
    v_dot2c_f32_bf16 v50, v149, v120
    v_dot2c_f32_bf16 v51, v149, v121
    v_dot2c_f32_bf16 v52, v150, v120
    v_dot2c_f32_bf16 v53, v150, v121
    v_dot2c_f32_bf16 v54, v151, v120
    v_dot2c_f32_bf16 v55, v151, v121
    s_branch L_attend
L_exitB:
    v_mov_b32 v122, 1
    s_mov_b64 exec, 1
    ds_add_rtn_u32 v122, v123, v122 offset:28744
    s_mov_b64 exec, -1
    v_dot2_f32_bf16 v68, v176, v56, 0
    v_dot2_f32_bf16 v69, v177, v57, 0
    v_dot2_f32_bf16 v70, v178, v58, 0
    v_dot2_f32_bf16 v71, v179, v59, 0
    v_dot2c_f32_bf16 v68, v180, v60
    v_dot2c_f32_bf16 v69, v181, v61
    v_dot2c_f32_bf16 v70, v182, v62
    v_dot2c_f32_bf16 v71, v183, v63
    v_dot2c_f32_bf16 v68, v184, v64
    v_dot2c_f32_bf16 v69, v185, v65
    v_dot2c_f32_bf16 v70, v186, v66
    v_dot2c_f32_bf16 v71, v187, v67
    s_nop 0
    v_add_f32 v68, v68, v69
    s_nop 0
    v_add_f32 v70, v70, v71
    v_add_f32 v72, v68, v70
    s_nop 1
    v_add_f32_dpp v72, v72, v72 quad_perm:[1,0,3,2] row_mask:0xf bank_mask:0xf
    s_nop 1
    v_add_f32_dpp v72, v72, v72 quad_perm:[2,3,0,1] row_mask:0xf bank_mask:0xf
    s_nop 1
    v_add_f32_dpp v72, v72, v72 row_half_mirror row_mask:0xf bank_mask:0xf
    v_cvt_pk_bf16_f32 v72, 0, v72
    v_mul_f32 v72, s68, v72
    v_cvt_pk_bf16_f32 v72, 0, v72
    s_waitcnt lgkmcnt(0)
    v_readfirstlane_b32 s60, v122
    s_cmp_lg_u32 s60, 0
    s_cbranch_scc1 L_ndB
    v_mov_b32 v13, 1
    s_mov_b64 exec, 1
    buffer_atomic_add v13, off, s[36:39], s61 sc0
    s_mov_b64 exec, -1
L_ndB:
    v_max_f32 v68, v11, v72
    v_mov_b32 v70, v68
    s_nop 1
    v_permlane32_swap_b32 v68, v70
    v_max_f32 v68, v68, v70
    v_mov_b32 v70, v68
    s_nop 1
    v_permlane16_swap_b32 v68, v70
    v_max_f32 v68, v68, v70
    s_nop 1
    v_max_f32_dpp v68, v68, v68 row_ror:8 row_mask:0xf bank_mask:0xf
    v_sub_f32 v74, v11, v68
    v_sub_f32 v76, v72, v68
    v_mul_f32 v74, s67, v74
    v_mul_f32 v76, s67, v76
    v_exp_f32 v74, v74
    v_exp_f32 v76, v76
    s_lshl_b32 s78, s56, 3
    v_fma_f32 v12, v12, v74, v76
    v_cvt_pk_bf16_f32 v120, v76, 0
    v_cvt_pk_bf16_f32 v121, 0, v76
    v_mov_b32 v70, v12
    v_pk_mul_f32 v[54:55], v[54:55], v[74:75] op_sel_hi:[1,0]
    v_pk_mul_f32 v[52:53], v[52:53], v[74:75] op_sel_hi:[1,0]
    v_permlane32_swap_b32 v12, v70
    v_pk_mul_f32 v[50:51], v[50:51], v[74:75] op_sel_hi:[1,0]
    v_pk_mul_f32 v[48:49], v[48:49], v[74:75] op_sel_hi:[1,0]
    v_add_f32 v12, v12, v70
    v_mov_b32 v70, v12
    v_pk_mul_f32 v[46:47], v[46:47], v[74:75] op_sel_hi:[1,0]
    v_pk_mul_f32 v[44:45], v[44:45], v[74:75] op_sel_hi:[1,0]
    v_permlane16_swap_b32 v12, v70
    v_pk_mul_f32 v[42:43], v[42:43], v[74:75] op_sel_hi:[1,0]
    v_pk_mul_f32 v[40:41], v[40:41], v[74:75] op_sel_hi:[1,0]
    v_add_f32 v12, v12, v70
    v_pk_mul_f32 v[38:39], v[38:39], v[74:75] op_sel_hi:[1,0]
    v_pk_mul_f32 v[36:37], v[36:37], v[74:75] op_sel_hi:[1,0]
    v_add_f32_dpp v12, v12, v12 row_ror:8 row_mask:0xf bank_mask:0xf
    v_pk_mul_f32 v[34:35], v[34:35], v[74:75] op_sel_hi:[1,0]
    v_pk_mul_f32 v[32:33], v[32:33], v[74:75] op_sel_hi:[1,0]
    v_mov_b32 v70, s78
    v_mov_b32 v69, v12
    v_lshlrev_b32 v14, 4, v1
    v_mov_b32 v16, 1
    v_lshlrev_b32 v15, 3, v3
    s_mov_b64 exec, 1
    ds_write_b64 v70, v[68:69] offset:28672
    s_mov_b64 exec, -1
    s_cmp_lg_u32 s60, 0
    s_cbranch_scc1 L_w0B
    s_waitcnt vmcnt(1)
    s_branch L_drB
L_w0B:
    s_waitcnt vmcnt(0)
L_drB:
    v_dot2c_f32_bf16 v32, v188, v120
    v_dot2c_f32_bf16 v33, v188, v121
    v_dot2c_f32_bf16 v34, v189, v120
    v_dot2c_f32_bf16 v35, v189, v121
    v_dot2c_f32_bf16 v36, v190, v120
    v_dot2c_f32_bf16 v37, v190, v121
    v_dot2c_f32_bf16 v38, v191, v120
    v_dot2c_f32_bf16 v39, v191, v121
    v_dot2c_f32_bf16 v40, v192, v120
    v_dot2c_f32_bf16 v41, v192, v121
    v_dot2c_f32_bf16 v42, v193, v120
    v_dot2c_f32_bf16 v43, v193, v121
    v_dot2c_f32_bf16 v44, v194, v120
    v_dot2c_f32_bf16 v45, v194, v121
    v_dot2c_f32_bf16 v46, v195, v120
    v_dot2c_f32_bf16 v47, v195, v121
    v_dot2c_f32_bf16 v48, v196, v120
    v_dot2c_f32_bf16 v49, v196, v121
    v_dot2c_f32_bf16 v50, v197, v120
    v_dot2c_f32_bf16 v51, v197, v121
    v_dot2c_f32_bf16 v52, v198, v120
    v_dot2c_f32_bf16 v53, v198, v121
    v_dot2c_f32_bf16 v54, v199, v120
    v_dot2c_f32_bf16 v55, v199, v121
L_attend:
    v_permlane32_swap_b32 v32, v36
    v_permlane32_swap_b32 v33, v37
    v_permlane32_swap_b32 v34, v38
    v_permlane32_swap_b32 v35, v39
    v_permlane32_swap_b32 v40, v44
    v_permlane32_swap_b32 v41, v45
    v_permlane32_swap_b32 v42, v46
    v_permlane32_swap_b32 v43, v47
    v_permlane32_swap_b32 v48, v52
    v_permlane32_swap_b32 v49, v53
    v_permlane32_swap_b32 v50, v54
    v_permlane32_swap_b32 v51, v55
    v_pk_add_f32 v[32:33], v[32:33], v[36:37]
    v_pk_add_f32 v[34:35], v[34:35], v[38:39]
    v_pk_add_f32 v[40:41], v[40:41], v[44:45]
    v_pk_add_f32 v[42:43], v[42:43], v[46:47]
    v_pk_add_f32 v[48:49], v[48:49], v[52:53]
    v_pk_add_f32 v[50:51], v[50:51], v[54:55]
    v_permlane16_swap_b32 v32, v34
    v_permlane16_swap_b32 v33, v35
    v_permlane16_swap_b32 v40, v42
    v_permlane16_swap_b32 v41, v43
    v_permlane16_swap_b32 v48, v50
    v_permlane16_swap_b32 v49, v51
    v_pk_add_f32 v[32:33], v[32:33], v[34:35]
    v_pk_add_f32 v[40:41], v[40:41], v[42:43]
    v_pk_add_f32 v[48:49], v[48:49], v[50:51]
    v_add_f32_dpp v80, v32, v32 row_ror:8 row_mask:0xf bank_mask:0x3
    v_add_f32_dpp v81, v40, v40 row_ror:8 row_mask:0xf bank_mask:0x3
    v_add_f32_dpp v82, v48, v48 row_ror:8 row_mask:0xf bank_mask:0x3
    v_add_f32_dpp v80, v33, v33 row_ror:8 row_mask:0xf bank_mask:0xc
    v_add_f32_dpp v81, v41, v41 row_ror:8 row_mask:0xf bank_mask:0xc
    v_add_f32_dpp v82, v49, v49 row_ror:8 row_mask:0xf bank_mask:0xc
    ds_write_b128 v228, v[80:83] offset:8192
    s_mov_b64 exec, 1
    ds_add_rtn_u32 v125, v123, v16 offset:28752
    s_mov_b64 exec, -1
    ds_read_b64 v[78:79], v15 offset:28672
    ds_read_b128 v[32:35], v14 offset:8192
    ds_read_b128 v[36:39], v14 offset:9216
    ds_read_b128 v[40:43], v14 offset:10240
    ds_read_b128 v[44:47], v14 offset:11264
    ds_read_b128 v[48:51], v14 offset:12288
    ds_read_b128 v[52:55], v14 offset:13312
    ds_read_b128 v[56:59], v14 offset:14336
    ds_read_b128 v[60:63], v14 offset:15360
    s_lshl_b32 s78, s2, 11
    s_add_u32 s78, s78, 327680
    v_mov_b32 v91, v7
    v_mov_b32 v17, 0
    s_waitcnt lgkmcnt(9)
    v_readfirstlane_b32 s86, v125
    s_cmp_eq_u32 s86, 7
    s_cbranch_scc1 L_comb
L_role:
    s_cmp_lg_u32 s60, 0
    s_cbranch_scc1 L_notfirst
    s_waitcnt vmcnt(0)
    v_add_u32 v13, 1, v13
    s_mov_b64 exec, 1
    ds_write_b32 v123, v13 offset:28736
    s_mov_b64 exec, -1
L_notfirst:
    s_mov_b32 s58, 0
    s_mov_b32 s69, 0
L_spin_tk:
    ds_read_b32 v14, v123 offset:28736
    s_waitcnt lgkmcnt(0)
    v_readfirstlane_b32 s94, v14
    s_cmp_lg_u32 s94, 0
    s_cbranch_scc1 L_gottk
    s_add_u32 s69, s69, 1
    s_cmp_lt_u32 s69, 2000
    s_cbranch_scc1 L_spin_tk
    s_branch L_barC
L_gottk:
    s_sub_u32 s94, s94, 1
    s_mul_i32 s94, s94, 4
    s_and_b32 s78, s2, 3
    s_add_u32 s94, s94, s78
    s_mov_b32 s58, 1
    s_cmp_ge_u32 s94, 200
    s_cbranch_scc1 L_barC
    s_mul_i32 s70, s94, 13108
    s_lshr_b32 s70, s70, 16
    s_mul_i32 s78, s70, 5
    s_sub_u32 s71, s94, s78
    s_cmp_lt_u32 s70, 32
    s_cselect_b32 s40, s12, s20
    s_cselect_b32 s41, s13, s21
    s_mov_b32 s42, 1966080
    s_cselect_b32 s42, 7864320, s42
    s_cselect_b32 s78, 0, 32
    s_cselect_b32 s79, 1, 24
    s_movk_i32 s80, 1280
    s_cselect_b32 s80, 81920, s80
    s_movk_i32 s81, 3840
    s_cselect_b32 s81, 10240, s81
    s_and_b32 s41, s41, 0xffff
    s_mov_b32 s43, 0x00020000
    s_cmp_ge_u32 s94, 200
    s_cselect_b32 s42, 0, s42
    s_sub_u32 s78, s70, s78
    s_mul_i32 s78, s78, 192
    s_mul_i32 s79, s56, s79
    v_mad_u32_u24 v6, v2, s81, v226
    v_mad_u32_u24 v224, v227, s81, v226
    s_add_u32 s78, s78, s79
    s_mul_i32 s63, s78, 1280
    s_lshl_b32 s79, s71, 8
    s_add_u32 s63, s63, s79
    s_add_u32 s75, s63, s80
    s_add_u32 s76, s75, s80
    s_cmp_lt_u32 s94, 80
    s_cselect_b32 s78, 0, 4
    s_cmp_ge_u32 s60, s78
    s_cbranch_scc1 L_barC
    buffer_load_dwordx4 v[96:99], v6, s[40:43], s63 offen nt
    buffer_load_dwordx4 v[108:111], v224, s[40:43], s63 offen nt
    buffer_load_dwordx4 v[100:103], v6, s[40:43], s75 offen nt
    buffer_load_dwordx4 v[112:115], v224, s[40:43], s75 offen nt
    buffer_load_dwordx4 v[104:107], v6, s[40:43], s76 offen nt
    buffer_load_dwordx4 v[116:119], v224, s[40:43], s76 offen nt
    s_mov_b32 s58, 2
L_barC:
    s_barrier
    s_cmp_lg_u32 s58, 0
    s_cbranch_scc1 L_haverole
    ds_read_b32 v14, v123 offset:28736
    s_waitcnt lgkmcnt(0)
    v_readfirstlane_b32 s94, v14
    s_sub_u32 s94, s94, 1
    s_mul_i32 s94, s94, 4
    s_and_b32 s78, s2, 3
    s_add_u32 s94, s94, s78
    s_cmp_ge_u32 s94, 200
    s_cbranch_scc1 L_reducer
    s_mul_i32 s70, s94, 13108
    s_lshr_b32 s70, s70, 16
    s_mul_i32 s78, s70, 5
    s_sub_u32 s71, s94, s78
    s_cmp_lt_u32 s70, 32
    s_cselect_b32 s40, s12, s20
    s_cselect_b32 s41, s13, s21
    s_mov_b32 s42, 1966080
    s_cselect_b32 s42, 7864320, s42
    s_cselect_b32 s78, 0, 32
    s_cselect_b32 s79, 1, 24
    s_movk_i32 s80, 1280
    s_cselect_b32 s80, 81920, s80
    s_movk_i32 s81, 3840
    s_cselect_b32 s81, 10240, s81
    s_and_b32 s41, s41, 0xffff
    s_mov_b32 s43, 0x00020000
    s_cmp_ge_u32 s94, 200
    s_cselect_b32 s42, 0, s42
    s_sub_u32 s78, s70, s78
    s_mul_i32 s78, s78, 192
    s_mul_i32 s79, s56, s79
    v_mad_u32_u24 v6, v2, s81, v226
    v_mad_u32_u24 v224, v227, s81, v226
    s_add_u32 s78, s78, s79
    s_mul_i32 s63, s78, 1280
    s_lshl_b32 s79, s71, 8
    s_add_u32 s63, s63, s79
    s_add_u32 s75, s63, s80
    s_add_u32 s76, s75, s80
L_haverole:
    s_cmp_ge_u32 s94, 200
    s_cbranch_scc1 L_reducer
    s_cmp_eq_u32 s58, 2
    s_cbranch_scc1 L_late2e
    buffer_load_dwordx4 v[96:99], v6, s[40:43], s63 offen nt
    buffer_load_dwordx4 v[108:111], v224, s[40:43], s63 offen nt
    buffer_load_dwordx4 v[100:103], v6, s[40:43], s75 offen nt
    buffer_load_dwordx4 v[112:115], v224, s[40:43], s75 offen nt
    buffer_load_dwordx4 v[104:107], v6, s[40:43], s76 offen nt
    buffer_load_dwordx4 v[116:119], v224, s[40:43], s76 offen nt
    v_lshlrev_b32 v164, 3, v1
    v_lshlrev_b32 v165, 4, v1
    v_mov_b32 v166, 1
    v_mov_b32 v162, v7
    v_mov_b32 v163, v7
    s_mul_i32 s87, s70, 5120
    s_lshl_b32 s78, s71, 10
    s_add_u32 s87, s87, s78
    s_add_u32 s87, s87, 1572864
    v_lshl_add_u32 v14, s56, 3, v2
    v_lshlrev_b32 v14, 4, v14
    s_lshl_b32 s78, s70, 14
    s_add_u32 s78, s78, 327680
    v_lshlrev_b32 v77, 11, v3
    v_add_u32 v77, s78, v77
    v_add_u32 v76, v77, v14
    s_mov_b32 s69, 0
    s_branch L_late2
L_late2e:
    v_lshlrev_b32 v164, 3, v1
    v_lshlrev_b32 v165, 4, v1
    v_mov_b32 v166, 1
    v_mov_b32 v162, v7
    v_mov_b32 v163, v7
    s_mul_i32 s87, s70, 5120
    s_lshl_b32 s78, s71, 10
    s_add_u32 s87, s87, s78
    s_add_u32 s87, s87, 1572864
    v_lshl_add_u32 v14, s56, 3, v2
    v_lshlrev_b32 v14, 4, v14
    s_lshl_b32 s78, s70, 14
    s_add_u32 s78, s78, 327680
    v_lshlrev_b32 v77, 11, v3
    v_add_u32 v77, s78, v77
    v_add_u32 v76, v77, v14
    s_mov_b32 s69, 0
    s_waitcnt vmcnt(0)
L_late2:
    s_barrier
    s_cmp_ge_u32 s70, 32
    s_cbranch_scc1 L_roleH
    buffer_load_dwordx4 v[68:71], v76, s[44:47], 0 offen sc1
    buffer_load_dwordx4 v[72:75], v77, s[44:47], 0 offen offset:1024 sc1
    s_waitcnt vmcnt(4)
    v_perm_b32 v144, v108, v96, s73
    v_perm_b32 v108, v108, v96, s74
    v_perm_b32 v145, v109, v97, s73
    v_perm_b32 v109, v109, v97, s74
    v_perm_b32 v146, v110, v98, s73
    v_perm_b32 v110, v110, v98, s74
    v_perm_b32 v147, v111, v99, s73
    v_perm_b32 v111, v111, v99, s74
    v_perm_b32 v148, v112, v100, s73
    v_perm_b32 v112, v112, v100, s74
    v_perm_b32 v149, v113, v101, s73
    v_perm_b32 v113, v113, v101, s74
    v_perm_b32 v150, v114, v102, s73
    v_perm_b32 v114, v114, v102, s74
    v_perm_b32 v151, v115, v103, s73
    v_perm_b32 v115, v115, v103, s74
    s_waitcnt vmcnt(2)
    v_perm_b32 v152, v116, v104, s73
    v_perm_b32 v116, v116, v104, s74
    v_perm_b32 v153, v117, v105, s73
    v_perm_b32 v117, v117, v105, s74
    v_perm_b32 v154, v118, v106, s73
    v_perm_b32 v118, v118, v106, s74
    v_perm_b32 v155, v119, v107, s73
    v_perm_b32 v119, v119, v107, s74
L_pollO:
    s_waitcnt vmcnt(0)
    v_cmp_ne_u32 vcc, s65, v71
    v_cmp_ne_u32 s[90:91], s65, v75
    s_or_b64 exec, vcc, s[90:91]
    s_cbranch_scc0 L_pollO_ok
    buffer_load_dwordx4 v[68:71], v76, s[44:47], 0 offen sc1
    buffer_load_dwordx4 v[72:75], v77, s[44:47], 0 offen offset:1024 sc1
    s_add_u32 s69, s69, 1
    s_cmp_lt_u32 s69, 20000
    s_cbranch_scc1 L_pollO
    s_waitcnt vmcnt(0)
L_pollO_ok:
    s_mov_b64 exec, -1
    v_max_f32_dpp v78, v72, v72 quad_perm:[1,0,3,2] row_mask:0xf bank_mask:0xf
    s_nop 1
    v_max_f32_dpp v78, v78, v78 quad_perm:[2,3,0,1] row_mask:0xf bank_mask:0xf
    s_nop 1
    v_max_f32_dpp v78, v78, v78 row_half_mirror row_mask:0xf bank_mask:0xf
    v_sub_f32 v72, v72, v78
    v_mul_f32 v72, s67, v72
    v_exp_f32 v72, v72
    s_nop 0
    v_mul_f32 v73, v73, v72
    v_pk_mul_f32 v[68:69], v[68:69], v[72:73] op_sel_hi:[1,0]
    v_mul_f32 v70, v70, v72
    v_add_f32_dpp v73, v73, v73 quad_perm:[1,0,3,2] row_mask:0xf bank_mask:0xf
    v_add_f32_dpp v68, v68, v68 quad_perm:[1,0,3,2] row_mask:0xf bank_mask:0xf
    v_add_f32_dpp v69, v69, v69 quad_perm:[1,0,3,2] row_mask:0xf bank_mask:0xf
    v_add_f32_dpp v70, v70, v70 quad_perm:[1,0,3,2] row_mask:0xf bank_mask:0xf
    v_add_f32_dpp v73, v73, v73 quad_perm:[2,3,0,1] row_mask:0xf bank_mask:0xf
    v_add_f32_dpp v68, v68, v68 quad_perm:[2,3,0,1] row_mask:0xf bank_mask:0xf
    v_add_f32_dpp v69, v69, v69 quad_perm:[2,3,0,1] row_mask:0xf bank_mask:0xf
    v_add_f32_dpp v70, v70, v70 quad_perm:[2,3,0,1] row_mask:0xf bank_mask:0xf
    v_add_f32_dpp v73, v73, v73 row_half_mirror row_mask:0xf bank_mask:0xf
    v_add_f32_dpp v68, v68, v68 row_half_mirror row_mask:0xf bank_mask:0xf
    v_add_f32_dpp v69, v69, v69 row_half_mirror row_mask:0xf bank_mask:0xf
    v_add_f32_dpp v70, v70, v70 row_half_mirror row_mask:0xf bank_mask:0xf
    v_rcp_f32 v73, v73
    s_nop 0
    v_mul_f32 v68, v68, v73
    v_mul_f32 v69, v69, v73
    v_mul_f32 v70, v70, v73
L_tile:
    v_mov_b32_dpp v81, v68 row_ror:8 row_mask:0xf bank_mask:0xf
    v_mov_b32_dpp v83, v69 row_ror:8 row_mask:0xf bank_mask:0xf
    v_mov_b32_dpp v85, v70 row_ror:8 row_mask:0xf bank_mask:0xf
    v_cvt_pk_bf16_f32 v80, v68, v81
    v_cvt_pk_bf16_f32 v82, v69, v83
    v_cvt_pk_bf16_f32 v84, v70, v85
    v_dot2_f32_bf16 v32, v144, v80, 0
    v_dot2_f32_bf16 v33, v108, v80, 0
    v_dot2_f32_bf16 v34, v145, v80, 0
    v_dot2_f32_bf16 v35, v109, v80, 0
    v_dot2_f32_bf16 v36, v146, v80, 0
    v_dot2_f32_bf16 v37, v110, v80, 0
    v_dot2_f32_bf16 v38, v147, v80, 0
    v_dot2_f32_bf16 v39, v111, v80, 0
    v_dot2c_f32_bf16 v32, v148, v82
    v_dot2c_f32_bf16 v33, v112, v82
    v_dot2c_f32_bf16 v34, v149, v82
    v_dot2c_f32_bf16 v35, v113, v82
    v_dot2c_f32_bf16 v36, v150, v82
    v_dot2c_f32_bf16 v37, v114, v82
    v_dot2c_f32_bf16 v38, v151, v82
    v_dot2c_f32_bf16 v39, v115, v82
    v_dot2c_f32_bf16 v32, v152, v84
    v_dot2c_f32_bf16 v33, v116, v84
    v_dot2c_f32_bf16 v34, v153, v84
    v_dot2c_f32_bf16 v35, v117, v84
    v_dot2c_f32_bf16 v36, v154, v84
    v_dot2c_f32_bf16 v37, v118, v84
    v_dot2c_f32_bf16 v38, v155, v84
    v_dot2c_f32_bf16 v39, v119, v84
    v_permlane32_swap_b32 v32, v36
    v_permlane32_swap_b32 v33, v37
    v_permlane32_swap_b32 v34, v38
    v_permlane32_swap_b32 v35, v39
    v_pk_add_f32 v[32:33], v[32:33], v[36:37]
    v_pk_add_f32 v[34:35], v[34:35], v[38:39]
    s_nop 1
    v_permlane16_swap_b32 v32, v34
    v_permlane16_swap_b32 v33, v35
    v_pk_add_f32 v[32:33], v[32:33], v[34:35]
    ds_write_b64 v225, v[32:33] offset:32768
    s_mov_b64 exec, 1
    ds_add_rtn_u32 v167, v123, v166 offset:28756
    s_mov_b64 exec, -1
    ds_read2st64_b64 v[168:171], v164 offset0:64 offset1:65
    ds_read2st64_b64 v[172:175], v164 offset0:66 offset1:67
    ds_read2st64_b64 v[176:179], v164 offset0:68 offset1:69
    ds_read2st64_b64 v[180:183], v164 offset0:70 offset1:71
    s_waitcnt lgkmcnt(4)
    v_readfirstlane_b32 s79, v167
    s_cmp_lg_u32 s79, 7
    s_cbranch_scc1 L_end
    s_waitcnt lgkmcnt(2)
    v_pk_add_f32 v[168:169], v[168:169], v[170:171]
    v_pk_add_f32 v[172:173], v[172:173], v[174:175]
    v_pk_add_f32 v[168:169], v[168:169], v[172:173]
    s_waitcnt lgkmcnt(0)
    v_pk_add_f32 v[176:177], v[176:177], v[178:179]
    v_pk_add_f32 v[180:181], v[180:181], v[182:183]
    v_pk_add_f32 v[176:177], v[176:177], v[180:181]
    v_pk_add_f32 v[160:161], v[168:169], v[176:177]
    buffer_store_dwordx4 v[160:163], v165, s[44:47], s87 offen sc1
    s_branch L_end
L_roleH:
    s_mul_i32 s78, s70, 5120
    s_add_u32 s78, s78, 65536
    v_min_u32 v77, 4, v3
    v_lshlrev_b32 v77, 10, v77
    v_add_u32 v76, v77, v14
    v_add_u32 v76, s78, v76
    v_add_u32 v77, 40960, v76
    s_mov_b32 s69, 0
    buffer_load_dwordx4 v[68:71], v76, s[44:47], 0 offen sc1
    buffer_load_dwordx4 v[72:75], v77, s[44:47], 0 offen sc1
    s_waitcnt vmcnt(4)
    v_perm_b32 v144, v108, v96, s73
    v_perm_b32 v108, v108, v96, s74
    v_perm_b32 v145, v109, v97, s73
    v_perm_b32 v109, v109, v97, s74
    v_perm_b32 v146, v110, v98, s73
    v_perm_b32 v110, v110, v98, s74
    v_perm_b32 v147, v111, v99, s73
    v_perm_b32 v111, v111, v99, s74
    v_perm_b32 v148, v112, v100, s73
    v_perm_b32 v112, v112, v100, s74
    v_perm_b32 v149, v113, v101, s73
    v_perm_b32 v113, v113, v101, s74
    v_perm_b32 v150, v114, v102, s73
    v_perm_b32 v114, v114, v102, s74
    v_perm_b32 v151, v115, v103, s73
    v_perm_b32 v115, v115, v103, s74
    s_waitcnt vmcnt(2)
    v_perm_b32 v152, v116, v104, s73
    v_perm_b32 v116, v116, v104, s74
    v_perm_b32 v153, v117, v105, s73
    v_perm_b32 v117, v117, v105, s74
    v_perm_b32 v154, v118, v106, s73
    v_perm_b32 v118, v118, v106, s74
    v_perm_b32 v155, v119, v107, s73
    v_perm_b32 v119, v119, v107, s74
    s_branch L_pollH_chk
L_pollH:
    buffer_load_dwordx4 v[68:71], v76, s[44:47], 0 offen sc1
    buffer_load_dwordx4 v[72:75], v77, s[44:47], 0 offen sc1
L_pollH_chk:
    s_waitcnt vmcnt(0)
    v_cmp_ne_u32 vcc, s65, v71
    v_cmp_ne_u32 s[90:91], s65, v75
    s_or_b64 vcc, vcc, s[90:91]
    s_cbranch_scc0 L_pollH_ok
    s_add_u32 s69, s69, 1
    s_cmp_lt_u32 s69, 20000
    s_cbranch_scc1 L_pollH
L_pollH_ok:
    v_cmp_gt_u32 vcc, 5, v3
    s_nop 1
    v_cndmask_b32 v68, 0, v68, vcc
    v_cndmask_b32 v72, 0, v72, vcc
    v_cndmask_b32 v69, 0, v69, vcc
    v_cndmask_b32 v73, 0, v73, vcc
    v_cndmask_b32 v70, 0, v70, vcc
    v_cndmask_b32 v74, 0, v74, vcc
    v_add_f32_dpp v68, v68, v68 quad_perm:[1,0,3,2] row_mask:0xf bank_mask:0xf
    v_add_f32_dpp v69, v69, v69 quad_perm:[1,0,3,2] row_mask:0xf bank_mask:0xf
    v_add_f32_dpp v70, v70, v70 quad_perm:[1,0,3,2] row_mask:0xf bank_mask:0xf
    v_add_f32_dpp v72, v72, v72 quad_perm:[1,0,3,2] row_mask:0xf bank_mask:0xf
    v_add_f32_dpp v73, v73, v73 quad_perm:[1,0,3,2] row_mask:0xf bank_mask:0xf
    v_add_f32_dpp v74, v74, v74 quad_perm:[1,0,3,2] row_mask:0xf bank_mask:0xf
    v_add_f32_dpp v68, v68, v68 quad_perm:[2,3,0,1] row_mask:0xf bank_mask:0xf
    v_add_f32_dpp v69, v69, v69 quad_perm:[2,3,0,1] row_mask:0xf bank_mask:0xf
    v_add_f32_dpp v70, v70, v70 quad_perm:[2,3,0,1] row_mask:0xf bank_mask:0xf
    v_add_f32_dpp v72, v72, v72 quad_perm:[2,3,0,1] row_mask:0xf bank_mask:0xf
    v_add_f32_dpp v73, v73, v73 quad_perm:[2,3,0,1] row_mask:0xf bank_mask:0xf
    v_add_f32_dpp v74, v74, v74 quad_perm:[2,3,0,1] row_mask:0xf bank_mask:0xf
    v_add_f32_dpp v68, v68, v68 row_half_mirror row_mask:0xf bank_mask:0xf
    v_add_f32_dpp v69, v69, v69 row_half_mirror row_mask:0xf bank_mask:0xf
    v_add_f32_dpp v70, v70, v70 row_half_mirror row_mask:0xf bank_mask:0xf
    v_add_f32_dpp v72, v72, v72 row_half_mirror row_mask:0xf bank_mask:0xf
    v_add_f32_dpp v73, v73, v73 row_half_mirror row_mask:0xf bank_mask:0xf
    v_add_f32_dpp v74, v74, v74 row_half_mirror row_mask:0xf bank_mask:0xf
    v_cvt_pk_bf16_f32 v68, 0, v68
    v_cvt_pk_bf16_f32 v72, 0, v72
    v_cvt_pk_bf16_f32 v69, 0, v69
    v_cvt_pk_bf16_f32 v73, 0, v73
    v_cvt_pk_bf16_f32 v70, 0, v70
    v_cvt_pk_bf16_f32 v74, 0, v74
    v_max_f32 v68, 0, v68
    v_max_f32 v69, 0, v69
    v_max_f32 v70, 0, v70
    v_mul_f32 v68, v68, v72
    v_mul_f32 v69, v69, v73
    v_mul_f32 v70, v70, v74
    s_branch L_tile
L_comb:
    s_waitcnt lgkmcnt(8)
    v_max_f32_dpp v84, v78, v78 quad_perm:[1,0,3,2] row_mask:0xf bank_mask:0xf
    s_nop 1
    v_max_f32_dpp v84, v84, v84 quad_perm:[2,3,0,1] row_mask:0xf bank_mask:0xf
    s_nop 1
    v_max_f32_dpp v84, v84, v84 row_half_mirror row_mask:0xf bank_mask:0xf
    v_sub_f32 v78, v78, v84
    v_mul_f32 v78, s67, v78
    v_exp_f32 v78, v78
    v_mov_b32 v92, v84
    v_mul_f32 v85, v78, v79
    v_mov_b32 v94, v7
    v_mov_b32 v95, v7
    s_waitcnt lgkmcnt(4)
    v_mul_f32_dpp v88, v78, v32 row_newbcast:0 row_mask:0xf bank_mask:0xf
    v_mul_f32_dpp v89, v78, v33 row_newbcast:0 row_mask:0xf bank_mask:0xf
    v_mul_f32_dpp v90, v78, v34 row_newbcast:0 row_mask:0xf bank_mask:0xf
    v_fmac_f32_dpp v88, v78, v36 row_newbcast:1 row_mask:0xf bank_mask:0xf
    v_fmac_f32_dpp v89, v78, v37 row_newbcast:1 row_mask:0xf bank_mask:0xf
    v_fmac_f32_dpp v90, v78, v38 row_newbcast:1 row_mask:0xf bank_mask:0xf
    v_add_f32_dpp v85, v85, v85 quad_perm:[1,0,3,2] row_mask:0xf bank_mask:0xf
    v_fmac_f32_dpp v88, v78, v40 row_newbcast:2 row_mask:0xf bank_mask:0xf
    v_fmac_f32_dpp v89, v78, v41 row_newbcast:2 row_mask:0xf bank_mask:0xf
    v_fmac_f32_dpp v90, v78, v42 row_newbcast:2 row_mask:0xf bank_mask:0xf
    v_add_f32_dpp v85, v85, v85 quad_perm:[2,3,0,1] row_mask:0xf bank_mask:0xf
    v_fmac_f32_dpp v88, v78, v44 row_newbcast:3 row_mask:0xf bank_mask:0xf
    v_fmac_f32_dpp v89, v78, v45 row_newbcast:3 row_mask:0xf bank_mask:0xf
    v_fmac_f32_dpp v90, v78, v46 row_newbcast:3 row_mask:0xf bank_mask:0xf
    v_add_f32_dpp v85, v85, v85 row_half_mirror row_mask:0xf bank_mask:0xf
    s_waitcnt lgkmcnt(0)
    v_fmac_f32_dpp v88, v78, v48 row_newbcast:4 row_mask:0xf bank_mask:0xf
    v_fmac_f32_dpp v89, v78, v49 row_newbcast:4 row_mask:0xf bank_mask:0xf
    v_fmac_f32_dpp v90, v78, v50 row_newbcast:4 row_mask:0xf bank_mask:0xf
    v_fmac_f32_dpp v88, v78, v52 row_newbcast:5 row_mask:0xf bank_mask:0xf
    v_fmac_f32_dpp v89, v78, v53 row_newbcast:5 row_mask:0xf bank_mask:0xf
    v_fmac_f32_dpp v90, v78, v54 row_newbcast:5 row_mask:0xf bank_mask:0xf
    v_fmac_f32_dpp v88, v78, v56 row_newbcast:6 row_mask:0xf bank_mask:0xf
    v_fmac_f32_dpp v89, v78, v57 row_newbcast:6 row_mask:0xf bank_mask:0xf
    v_fmac_f32_dpp v90, v78, v58 row_newbcast:6 row_mask:0xf bank_mask:0xf
    v_fmac_f32_dpp v88, v78, v60 row_newbcast:7 row_mask:0xf bank_mask:0xf
    v_fmac_f32_dpp v89, v78, v61 row_newbcast:7 row_mask:0xf bank_mask:0xf
    v_fmac_f32_dpp v90, v78, v62 row_newbcast:7 row_mask:0xf bank_mask:0xf
    buffer_store_dwordx4 v[88:91], v14, s[44:47], s78 offen sc1
    v_mov_b32 v93, v85
    s_mov_b64 exec, 1
    buffer_store_dwordx4 v[92:95], v17, s[44:47], s78 offen offset:1024 sc1
    s_mov_b64 exec, -1
    s_mov_b32 s58, 0
    s_cmp_lt_u32 s60, 4
    s_cbranch_scc1 L_role
    s_branch L_barC
L_reducer:
    s_cmp_ge_u32 s94, 240
    s_cbranch_scc1 L_end
    s_cmp_lg_u32 s56, 1
    s_cbranch_scc1 L_end
    s_sub_u32 s78, s94, 200
    s_lshr_b32 s79, s78, 3
    s_lshl_b32 s79, s79, 10
    s_and_b32 s80, s78, 7
    s_lshl_b32 s80, s80, 7
    s_add_u32 s79, s79, s80
    s_add_u32 s79, s79, 1572864
    v_mul_u32_u24 v14, 5120, v2
    v_lshl_add_u32 v14, v3, 4, v14
    s_add_u32 s80, s79, 0
    s_add_u32 s81, s79, 40960
    s_add_u32 s82, s79, 81920
    s_add_u32 s83, s79, 122880
    s_add_u32 s84, s79, 163840
    v_bfe_u32 v15, v1, 4, 1
    v_lshl_add_u32 v15, v3, 1, v15
    v_lshlrev_b32 v15, 1, v15
    s_lshl_b32 s85, s78, 5
    buffer_load_ushort v16, v15, s[48:51], s85 offen
    s_mov_b32 s69, 0
    buffer_load_dwordx4 v[128:131], v14, s[44:47], s80 offen sc1
    buffer_load_dwordx4 v[132:135], v14, s[44:47], s81 offen sc1
    buffer_load_dwordx4 v[136:139], v14, s[44:47], s82 offen sc1
    buffer_load_dwordx4 v[140:143], v14, s[44:47], s83 offen sc1
    buffer_load_dwordx4 v[144:147], v14, s[44:47], s84 offen sc1
L_pollB:
    s_waitcnt vmcnt(0)
    v_cmp_ne_u32 vcc, s65, v146
    s_cbranch_vccz L_gotB
    buffer_load_dwordx4 v[128:131], v14, s[44:47], s80 offen sc1
    buffer_load_dwordx4 v[132:135], v14, s[44:47], s81 offen sc1
    buffer_load_dwordx4 v[136:139], v14, s[44:47], s82 offen sc1
    buffer_load_dwordx4 v[140:143], v14, s[44:47], s83 offen sc1
    buffer_load_dwordx4 v[144:147], v14, s[44:47], s84 offen sc1
    s_add_u32 s69, s69, 1
    s_cmp_lt_u32 s69, 20000
    s_cbranch_scc1 L_pollB
L_gotB:
    v_xor_b32 v76, v130, v7
    v_xor_b32 v77, v134, v7
    v_xor_b32 v78, v138, v7
    v_xor_b32 v79, v142, v7
    v_or3_b32 v76, v76, v77, v78
    v_or_b32 v76, v76, v79
    v_cmp_ne_u32 vcc, 0, v76
    s_mov_b64 s[86:87], vcc
    s_cbranch_vccz L_gotB2
    buffer_load_dwordx4 v[128:131], v14, s[44:47], s80 offen sc1
    buffer_load_dwordx4 v[132:135], v14, s[44:47], s81 offen sc1
    buffer_load_dwordx4 v[136:139], v14, s[44:47], s82 offen sc1
    buffer_load_dwordx4 v[140:143], v14, s[44:47], s83 offen sc1
L_gotB2:
    v_mov_b32 v74, v144
    v_mov_b32 v75, v145
    s_nop 1
    v_permlane16_swap_b32 v74, v75
    v_add_f32 v74, v74, v75
    v_mov_b32 v75, v74
    s_nop 1
    v_permlane32_swap_b32 v74, v75
    v_add_f32 v74, v74, v75
    s_nop 1
    v_add_f32_dpp v69, v74, v74 row_ror:8 row_mask:0xf bank_mask:0xf
    v_cvt_pk_bf16_f32 v69, 0, v69
    v_mul_f32 v70, s67, v69
    v_sub_f32 v70, 0, v70
    v_exp_f32 v70, v70
    s_nop 0
    v_add_f32 v70, 1.0, v70
    v_rcp_f32 v70, v70
    s_nop 0
    v_mul_f32 v69, v69, v70
    v_cvt_pk_bf16_f32 v69, 0, v69
    v_lshlrev_b32 v16, 16, v16
    s_cmp_eq_u64 s[86:87], 0
    s_cbranch_scc1 L_pollS_ok
L_pollS:
    s_waitcnt vmcnt(0)
    v_xor_b32 v76, v130, v7
    v_xor_b32 v77, v134, v7
    v_xor_b32 v78, v138, v7
    v_xor_b32 v79, v142, v7
    v_or3_b32 v76, v76, v77, v78
    v_or_b32 v76, v76, v79
    v_cmp_ne_u32 vcc, 0, v76
    s_cbranch_vccz L_pollS_ok
    buffer_load_dwordx4 v[128:131], v14, s[44:47], s80 offen sc1
    buffer_load_dwordx4 v[132:135], v14, s[44:47], s81 offen sc1
    buffer_load_dwordx4 v[136:139], v14, s[44:47], s82 offen sc1
    buffer_load_dwordx4 v[140:143], v14, s[44:47], s83 offen sc1
    s_add_u32 s69, s69, 1
    s_cmp_lt_u32 s69, 20000
    s_cbranch_scc1 L_pollS
L_pollS_ok:
    v_pk_add_f32 v[72:73], v[128:129], v[132:133]
    v_pk_add_f32 v[76:77], v[136:137], v[140:141]
    v_pk_add_f32 v[72:73], v[72:73], v[76:77]
    s_nop 1
    v_permlane16_swap_b32 v72, v73
    v_add_f32 v72, v72, v73
    v_mov_b32 v73, v72
    s_nop 1
    v_permlane32_swap_b32 v72, v73
    v_add_f32 v72, v72, v73
    s_nop 1
    v_add_f32_dpp v68, v72, v72 row_ror:8 row_mask:0xf bank_mask:0xf
    v_cvt_pk_bf16_f32 v68, 0, v68
    v_mul_f32 v68, v68, v69
    v_cvt_pk_bf16_f32 v68, 0, v68
    v_add_f32 v68, v68, v16
    v_cvt_pk_bf16_f32 v68, v68, v68
    s_mov_b32 exec_lo, 0x00ff00ff
    s_mov_b32 exec_hi, 0
    buffer_store_short v68, v15, s[52:55], s85 offen
    s_cmp_lg_u32 s94, 200
    s_cbranch_scc1 L_red_end
    s_add_u32 s78, s66, 1
    v_mov_b32 v71, s78
    s_mov_b64 exec, 1
    buffer_store_dword v71, off, s[44:47], 0 sc1
L_red_end:
L_end:
    s_waitcnt lgkmcnt(0)
L_exit:
    s_endpgm
L_codeend:
    s_endpgm
.section .rodata,"a"
.p2align 6
.amdhsa_kernel recurrent_scan__sliding_block_cached__glu_gated_reglu__decode_kernel
  .amdhsa_next_free_vgpr 256
  .amdhsa_next_free_sgpr 102
  .amdhsa_accum_offset 256
  .amdhsa_group_segment_fixed_size 0
  .amdhsa_kernarg_size 96
  .amdhsa_user_sgpr_count 2
  .amdhsa_user_sgpr_kernarg_segment_ptr 1
  .amdhsa_system_sgpr_workgroup_id_x 1
.end_amdhsa_kernel
```
